```python
import torch

def _softmax(x, axis=-1):
    return torch.softmax(x, dim=axis)
def _gelu(x):
    return torch.nn.functional.gelu(x, approximate="tanh")
def _silu(x):
    return torch.nn.functional.silu(x)
def _sigmoid(x):
    return torch.sigmoid(x)
def _layernorm(x, axis=-1, eps=1e-5):
    m = x.mean(dim=axis, keepdim=True)
    v = x.var(dim=axis, keepdim=True, unbiased=False)
    return (x - m) / torch.sqrt(v + eps)
def _scatter_add(tgt, idx, src, axis=0):
    return tgt.clone().index_add_(axis, idx, src)
def _segment_sum(src, seg, n):
    out = torch.zeros((n,) + src.shape[1:], dtype=src.dtype)
    return out.index_add_(0, seg, src)
def _pad(x, pw):
    flat = tuple(v for pair in reversed(pw) for v in pair)
    return torch.nn.functional.pad(x, flat)

kernel_name = 'sequential_preLN__sliding_block_cached__dense_activation_relu__decode'

def setup_inputs():

    _w = (lambda a: (lambda t: t.to(torch.bfloat16) if t.is_floating_point() else t)(torch.as_tensor(a)))
    def _A_setup():
        B, Sq, D = 8, 1, 640
        Hq, Hkv, Sk, Dh = 32, 32, 4096, 128
        assert Hq % Hkv == 0, (Hq, Hkv)
        return {
            "x": _w((lambda *s: torch.randn(*s, dtype=torch.bfloat16) * 0.05)(B, Sq, D)),
            "k_cache": _w((lambda *s: torch.randn(*s, dtype=torch.bfloat16) * 3.2)(B, Hkv, Sk, Dh)),
            "v_cache": _w((lambda *s: torch.randn(*s, dtype=torch.bfloat16) * 0.4)(B, Hkv, Sk, Dh)),
            "wq": _w((lambda *s: torch.randn(*s, dtype=torch.bfloat16) * 3.2)(D, Hq * Dh) * (D ** -0.5)),
            "wo": _w((lambda *s: torch.randn(*s, dtype=torch.bfloat16) * 0.4)(Hq * Dh, D) * ((Hq * Dh) ** -0.5)),
        }
    _A_in = _A_setup()

    def _B_setup():
        B, S, D, Dff = 8, 1, 640, 1728
        return {
            "x": _w((lambda *s: torch.randn(*s, dtype=torch.bfloat16) * 0.05)(B, S, D)),
            "w1": _w((lambda *s: torch.randn(*s, dtype=torch.bfloat16) * 0.05)(D, Dff)),
            "w2": _w((lambda *s: torch.randn(*s, dtype=torch.bfloat16) * 0.05)(Dff, D)),
        }
    _B_in = _B_setup()

    return {
        "A_x": _A_in["x"],
        "A_k_cache": _A_in["k_cache"],
        "A_v_cache": _A_in["v_cache"],
        "A_wq": _A_in["wq"],
        "A_wo": _A_in["wo"],
        "B_x": _B_in["x"],
        "B_w1": _B_in["w1"],
        "B_w2": _B_in["w2"],
    }

def reference(A_x, A_k_cache, A_v_cache, A_wq, A_wo, B_x, B_w1, B_w2):
    def _A_ref(x, k_cache, v_cache, wq, wo):
        B, Sq, D = x.shape
        Hq, Dh = 32, 128
        Hkv, Sk = k_cache.shape[1], k_cache.shape[2]
        W = min(4096, max(256, Sk // 4))
        rep = Hq // Hkv
        q = (lambda x, *d: x.permute(*d))((x @ wq).reshape(B, Sq, Hq, Dh), 0, 2, 1, 3)
        k = (lambda x, n, axis: torch.repeat_interleave(x, n, dim=axis))(k_cache[:, :, Sk - W:, :], rep, axis=1)
        v = (lambda x, n, axis: torch.repeat_interleave(x, n, dim=axis))(v_cache[:, :, Sk - W:, :], rep, axis=1)
        scores = torch.einsum("bhqd,bhkd->bhqk", q, k) * (Dh ** -0.5)
        p = _softmax(scores, axis=-1)
        o = torch.einsum("bhqk,bhkd->bhqd", p, v)
        return (lambda x, *d: x.permute(*d))(o, 0, 2, 1, 3).reshape(B, Sq, Hq * Dh) @ wo

    def _B_ref(x, w1, w2):
        h = torch.einsum("bsd,df->bsf", x, w1)
        zero = torch.zeros_like(h)
        h = torch.maximum(h, zero)
        return torch.einsum("bsf,fd->bsd", h, w2)

    x = A_x
    h = x + _A_ref(_layernorm(x, axis=-1), A_k_cache, A_v_cache, A_wq, A_wo)
    h2 = h + _B_ref(_layernorm(h, axis=-1), B_w1, B_w2)
    return h2
```

```asm
; @launch grid=(256,1,1) block=(512,1,1) lds=150528
.amdgcn_target "amdgcn-amd-amdhsa--gfx950"
.text
.globl sequential_preLN__sliding_block_cached__dense_activation_relu__decode_kernel
.p2align 8
.type sequential_preLN__sliding_block_cached__dense_activation_relu__decode_kernel,@function
sequential_preLN__sliding_block_cached__dense_activation_relu__decode_kernel:
    s_cmp_ge_u32 s2, 256
    s_cbranch_scc1 L_end
    s_load_dwordx16 s[4:19], s[0:1], 0
    s_load_dwordx4 s[20:23], s[0:1], 64
    s_load_dwordx2 s[24:25], s[0:1], 80
    v_lshrrev_b32 v28, 6, v0
    v_and_b32 v0, 63, v0
    v_readfirstlane_b32 s3, v28
    s_and_b32 s26, s2, 0xe1
    s_bfe_u32 s65, s2, 0x30002
    s_lshl1_add_u32 s26, s65, s26
    s_and_b32 s65, s2, 2
    s_lshl3_add_u32 s26, s65, s26
    v_lshlrev_b32 v1, 4, v0
    s_lshl_b32 s64, s26, 20
    s_add_u32 s64, s64, 0xc0000
    s_and_b32 s65, s2, 8
    s_add_u32 s101, s65, s3
    s_lshl_b32 s101, s101, 10
    s_lshl_b32 s65, s65, 11
    s_sub_u32 s66, 8192, s65
    s_add_u32 s67, 8192, s65
    s_mov_b32 s100, s101
    s_mov_b32 s30, 0x40000
    s_mov_b32 s31, 0x20000
    s_waitcnt lgkmcnt(0)
    s_add_u32 s28, s6, s64
    s_addc_u32 s29, s7, 0
    s_and_b32 s29, s29, 0xffff
    buffer_load_dwordx4 v[48:51], v1, s[28:31], s101 offen nt
    s_add_u32 s101, s101, s66
    buffer_load_dwordx4 v[52:55], v1, s[28:31], s101 offen nt
    s_add_u32 s101, s101, s67
    buffer_load_dwordx4 v[56:59], v1, s[28:31], s101 offen nt
    s_add_u32 s101, s101, s66
    buffer_load_dwordx4 v[60:63], v1, s[28:31], s101 offen nt
    s_mov_b64 s[0:1], s[66:67]
    s_lshr_b32 s27, s2, 5
    s_and_b32 s26, s26, 31
    v_mul_u32_u24 v30, 20, v0
    s_mul_i32 s67, s27, 1280
    s_lshl_b32 s65, s26, 8
    s_mul_i32 s66, s26, 163840
    v_lshrrev_b32 v28, 4, v0
    v_and_b32 v29, 15, v0
    v_lshlrev_b32 v2, 13, v28
    v_lshl_add_u32 v2, v29, 4, v2
    s_cmp_gt_u32 s3, 1
    s_nop 0
    s_cbranch_scc1 L_nopf
    s_cmp_ge_u32 s2, 16
    s_cbranch_scc1 L_nopf
    s_getpc_b64 s[56:57]
L_pc:
    s_lshl_b32 s60, s3, 13
    v_lshlrev_b32 v12, 7, v0
    v_add_u32 v12, s60, v12
    v_min_u32 v12, L_codeend-L_pc-4, v12
    v_mov_b32 v15, s57
    v_add_co_u32 v14, vcc, s56, v12
    s_nop 1
    v_addc_co_u32 v15, vcc, 0, v15, vcc
    global_load_dword v47, v[14:15], off
L_nopf:
    s_mov_b32 s44, s4
    s_and_b32 s45, s5, 0xffff
    s_mov_b32 s46, 10240
    s_mov_b32 s47, 0x20000
    buffer_load_dwordx4 v[32:35], v30, s[44:47], s67 offen
    buffer_load_dword v36, v30, s[44:47], s67 offen offset:16
    s_add_u32 s36, s10, s65
    s_addc_u32 s37, s11, 0
    s_and_b32 s37, s37, 0xffff
    s_mov_b32 s38, 5234944
    s_mov_b32 s39, 0x20000
    s_add_u32 s32, s8, s64
    s_addc_u32 s33, s9, 0
    s_and_b32 s33, s33, 0xffff
    s_mov_b32 s34, 262144
    s_mov_b32 s35, 0x20000
    s_add_u32 s40, s12, s66
    s_addc_u32 s41, s13, 0
    s_and_b32 s41, s41, 0xffff
    s_mov_b32 s42, 163840
    s_mov_b32 s43, 0x20000
    s_mov_b32 s48, s24
    s_and_b32 s49, s25, 0xffff
    s_mov_b32 s50, 4194304
    s_mov_b32 s51, 0x20000
    s_mov_b32 s52, s22
    s_and_b32 s53, s23, 0xffff
    s_mov_b32 s54, 256
    s_mov_b32 s55, 0x20000
    s_mov_b32 s60, s20
    s_and_b32 s61, s21, 0xffff
    s_mov_b32 s62, 10240
    s_mov_b32 s63, 0x20000
    s_add_u32 s64, s24, 32768
    s_addc_u32 s65, s25, 0
    s_and_b32 s65, s65, 0xffff
    s_mov_b32 s66, 27648
    s_mov_b32 s67, 0x20000
    s_add_u32 s12, s101, s1
    s_mov_b32 s13, s100
    s_mov_b32 s100, 0
    s_lshl_b32 s15, s3, 15
    s_mul_i32 s14, s27, 10
    s_lshr_b32 s14, s14, 3
    s_lshl_b32 s14, s14, 19
    s_add_u32 s14, s14, s15
    s_mul_i32 s20, s3, 1280
    buffer_load_dwordx4 v[64:67], v2, s[36:39], s14 offen
    s_add_u32 s14, s14, 262144
    s_mov_b32 s9, 0x40000
    s_mov_b32 s10, 0x00ff00ff
    s_mov_b32 s11, 0x00ff00ff
    v_mul_u32_u24 v3, 40960, v28
    v_and_b32 v12, 1, v29
    v_lshrrev_b32 v13, 1, v29
    v_lshl_add_u32 v3, v29, 4, v3
    v_lshlrev_b32 v12, 4, v12
    v_mov_b32 v14, 0xffff
    v_lshlrev_b32 v12, v12, v14
    v_and_b32 v13, 3, v13
    v_cmp_eq_u32 vcc, 0, v13
    s_nop 1
    v_cndmask_b32 v4, 0, v12, vcc
    v_cmp_eq_u32 vcc, 1, v13
    s_nop 1
    v_cndmask_b32 v5, 0, v12, vcc
    v_cmp_eq_u32 vcc, 2, v13
    s_waitcnt vmcnt(4)
    buffer_load_dwordx4 v[68:71], v1, s[28:31], s12 offen nt
    s_add_u32 s12, s12, s0
    v_cndmask_b32 v6, 0, v12, vcc
    v_cmp_eq_u32 vcc, 3, v13
    s_nop 1
    v_cndmask_b32 v7, 0, v12, vcc
    v_lshrrev_b32 v12, 3, v29
    s_lshl_b32 s4, s3, 1
    v_add_u32 v12, s4, v12
    v_mul_u32_u24 v30, 528, v12
    v_and_b32 v12, 7, v29
    v_lshl_add_u32 v30, v12, 6, v30
    v_lshl_add_u32 v30, v28, 4, v30
    v_mul_u32_u24 v31, 528, v29
    v_lshl_add_u32 v31, v28, 4, v31
    s_lshl_b32 s4, s3, 6
    v_add_u32 v31, s4, v31
    s_waitcnt vmcnt(4)
    buffer_load_dwordx4 v[72:75], v2, s[36:39], s14 offen
    s_add_u32 s14, s14, 262144
    s_cmp_ge_u32 s14, 5242880
    s_cselect_b32 s14, s15, s14
    s_waitcnt vmcnt(4)
    buffer_load_dwordx4 v[76:79], v1, s[28:31], s12 offen nt
    s_add_u32 s12, s12, s1
    s_waitcnt vmcnt(4)
    buffer_load_dwordx4 v[80:83], v2, s[36:39], s14 offen
    s_add_u32 s14, s14, 262144
    v_lshlrev_b32 v8, 16, v32
    v_and_b32 v9, 0xffff0000, v32
    v_lshlrev_b32 v10, 16, v33
    v_and_b32 v11, 0xffff0000, v33
    v_lshlrev_b32 v12, 16, v34
    v_and_b32 v13, 0xffff0000, v34
    v_lshlrev_b32 v14, 16, v35
    v_and_b32 v15, 0xffff0000, v35
    v_lshlrev_b32 v16, 16, v36
    v_and_b32 v17, 0xffff0000, v36
    v_add_f32 v20, v8, v9
    v_add_f32 v21, v10, v11
    v_add_f32 v20, v20, v12
    v_add_f32 v21, v21, v13
    v_add_f32 v20, v20, v14
    v_add_f32 v21, v21, v15
    s_waitcnt vmcnt(4)
    buffer_load_dwordx4 v[84:87], v1, s[28:31], s12 offen nt
    s_add_u32 s12, s12, s0
    v_add_f32 v20, v20, v16
    v_add_f32 v21, v21, v17
    v_add_f32 v20, v20, v21
    v_mov_b32 v22, 0x3acccccd
    s_nop 0
    v_add_f32_dpp v20, v20, v20 row_ror:8 row_mask:0xf bank_mask:0xf
    s_nop 1
    v_add_f32_dpp v20, v20, v20 row_ror:4 row_mask:0xf bank_mask:0xf
    s_nop 1
    v_add_f32_dpp v20, v20, v20 row_ror:2 row_mask:0xf bank_mask:0xf
    s_nop 1
    v_add_f32_dpp v20, v20, v20 row_ror:1 row_mask:0xf bank_mask:0xf
    s_nop 1
    v_add_f32_dpp v20, v20, v20 row_bcast:15 row_mask:0xa bank_mask:0xf
    s_nop 1
    v_add_f32_dpp v20, v20, v20 row_bcast:31 row_mask:0xc bank_mask:0xf
    s_nop 0
    v_readlane_b32 s4, v20, 63
    s_nop 1
    v_mul_f32 v18, s4, v22
    v_sub_f32 v21, v8, v18
    v_sub_f32 v19, v9, v18
    v_mul_f32 v20, v21, v21
    v_fmac_f32 v20, v19, v19
    s_waitcnt vmcnt(4)
    buffer_load_dwordx4 v[88:91], v1, s[28:31], s12 offen nt
    s_add_u32 s12, s12, s1
    v_sub_f32 v21, v10, v18
    v_sub_f32 v19, v11, v18
    v_fmac_f32 v20, v21, v21
    v_fmac_f32 v20, v19, v19
    v_sub_f32 v21, v12, v18
    v_sub_f32 v19, v13, v18
    v_fmac_f32 v20, v21, v21
    v_fmac_f32 v20, v19, v19
    v_sub_f32 v21, v14, v18
    v_sub_f32 v19, v15, v18
    v_fmac_f32 v20, v21, v21
    v_fmac_f32 v20, v19, v19
    v_sub_f32 v21, v16, v18
    v_sub_f32 v19, v17, v18
    v_fmac_f32 v20, v21, v21
    v_fmac_f32 v20, v19, v19
    s_waitcnt vmcnt(4)
    buffer_load_dwordx4 v[92:95], v2, s[36:39], s14 offen
    s_add_u32 s14, s14, 262144
    s_cmp_ge_u32 s14, 5242880
    s_cselect_b32 s14, s15, s14
    v_add_f32_dpp v20, v20, v20 row_ror:8 row_mask:0xf bank_mask:0xf
    s_nop 1
    v_add_f32_dpp v20, v20, v20 row_ror:4 row_mask:0xf bank_mask:0xf
    s_nop 1
    v_add_f32_dpp v20, v20, v20 row_ror:2 row_mask:0xf bank_mask:0xf
    s_nop 1
    v_add_f32_dpp v20, v20, v20 row_ror:1 row_mask:0xf bank_mask:0xf
    s_nop 1
    v_add_f32_dpp v20, v20, v20 row_bcast:15 row_mask:0xa bank_mask:0xf
    s_nop 1
    v_add_f32_dpp v20, v20, v20 row_bcast:31 row_mask:0xc bank_mask:0xf
    s_nop 0
    v_readlane_b32 s4, v20, 63
    v_cvt_pk_bf16_f32 v18, v18, v18
    v_and_b32 v18, 0xffff0000, v18
    v_mul_f32 v20, s4, v22
    v_cvt_pk_bf16_f32 v20, v20, v20
    v_and_b32 v20, 0xffff0000, v20
    v_add_f32 v20, 0x3727c5ac, v20
    v_cvt_pk_bf16_f32 v20, v20, v20
    v_and_b32 v20, 0xffff0000, v20
    v_sqrt_f32 v20, v20
    s_waitcnt vmcnt(4)
    buffer_load_dwordx4 v[96:99], v1, s[28:31], s12 offen nt
    s_add_u32 s12, s12, s0
    v_cvt_pk_bf16_f32 v20, v20, v20
    v_and_b32 v20, 0xffff0000, v20
    v_rcp_f32 v19, v20
    v_sub_f32 v8, v8, v18
    v_sub_f32 v9, v9, v18
    v_sub_f32 v10, v10, v18
    v_sub_f32 v11, v11, v18
    v_sub_f32 v12, v12, v18
    v_sub_f32 v13, v13, v18
    v_sub_f32 v14, v14, v18
    v_sub_f32 v15, v15, v18
    v_sub_f32 v16, v16, v18
    v_sub_f32 v17, v17, v18
    v_cvt_pk_bf16_f32 v9, v8, v9
    v_cvt_pk_bf16_f32 v11, v10, v11
    v_cvt_pk_bf16_f32 v13, v12, v13
    s_waitcnt vmcnt(4)
    buffer_load_dwordx4 v[100:103], v2, s[36:39], s14 offen
    s_add_u32 s14, s14, 262144
    v_cvt_pk_bf16_f32 v15, v14, v15
    v_cvt_pk_bf16_f32 v17, v16, v17
    v_lshlrev_b32 v8, 16, v9
    v_and_b32 v9, 0xffff0000, v9
    v_lshlrev_b32 v10, 16, v11
    v_and_b32 v11, 0xffff0000, v11
    v_lshlrev_b32 v12, 16, v13
    v_and_b32 v13, 0xffff0000, v13
    v_lshlrev_b32 v14, 16, v15
    v_and_b32 v15, 0xffff0000, v15
    v_lshlrev_b32 v16, 16, v17
    v_and_b32 v17, 0xffff0000, v17
    v_mul_f32 v8, v8, v19
    v_mul_f32 v9, v9, v19
    v_mul_f32 v10, v10, v19
    v_mul_f32 v11, v11, v19
    s_waitcnt vmcnt(4)
    buffer_load_dwordx4 v[104:107], v1, s[28:31], s12 offen nt
    s_add_u32 s12, s12, s1
    v_mul_f32 v12, v12, v19
    v_mul_f32 v13, v13, v19
    v_mul_f32 v14, v14, v19
    v_mul_f32 v15, v15, v19
    v_mul_f32 v16, v16, v19
    v_mul_f32 v17, v17, v19
    v_cvt_pk_bf16_f32 v32, v8, v9
    v_cvt_pk_bf16_f32 v33, v10, v11
    v_cvt_pk_bf16_f32 v34, v12, v13
    v_cvt_pk_bf16_f32 v35, v14, v15
    v_cvt_pk_bf16_f32 v36, v16, v17
    s_mul_i32 s4, s3, 2816
    v_mul_u32_u24 v20, 20, v0
    v_add_u32 v20, s4, v20
    ds_write_b32 v20, v32 offset:35840
    ds_write_b32 v20, v33 offset:35844
    s_waitcnt vmcnt(4)
    buffer_load_dwordx4 v[108:111], v1, s[28:31], s12 offen nt
    s_add_u32 s12, s12, s0
    ds_write_b32 v20, v34 offset:35848
    ds_write_b32 v20, v35 offset:35852
    ds_write_b32 v20, v36 offset:35856
    ds_write_b32 v20, v32 offset:37120
    ds_write_b32 v20, v33 offset:37124
    ds_write_b32 v20, v34 offset:37128
    ds_write_b32 v20, v35 offset:37132
    ds_write_b32 v20, v36 offset:37136
    v_lshrrev_b32 v21, 3, v29
    v_lshlrev_b32 v21, 6, v21
    v_lshl_add_u32 v21, v28, 1, v21
    s_mul_i32 s4, s3, 2824
    s_mul_i32 s5, s27, 10
    s_lshr_b32 s5, s5, 3
    s_lshl_b32 s5, s5, 7
    s_add_u32 s4, s4, s5
    s_waitcnt vmcnt(4)
    buffer_load_dwordx4 v[112:115], v2, s[36:39], s14 offen
    s_add_u32 s14, s14, 262144
    s_cmp_ge_u32 s14, 5242880
    s_cselect_b32 s14, s15, s14
    v_add_u32 v21, s4, v21
    s_waitcnt lgkmcnt(0)
    ds_read_u16 v32, v21 offset:35840
    ds_read_u16 v33, v21 offset:35968
    ds_read_u16 v34, v21 offset:36096
    ds_read_u16 v35, v21 offset:36224
    ds_read_u16 v36, v21 offset:36352
    ds_read_u16 v37, v21 offset:36480
    ds_read_u16 v38, v21 offset:36608
    ds_read_u16 v39, v21 offset:36736
    ds_read_u16 v40, v21 offset:36864
    ds_read_u16 v41, v21 offset:36992
    s_waitcnt lgkmcnt(0)
    v_lshl_or_b32 v32, v32, 16, v32
    v_lshl_or_b32 v33, v33, 16, v33
    v_lshl_or_b32 v34, v34, 16, v34
    s_waitcnt vmcnt(4)
    buffer_load_dwordx4 v[116:119], v1, s[28:31], s12 offen nt
    s_add_u32 s12, s12, s1
    v_lshl_or_b32 v35, v35, 16, v35
    v_lshl_or_b32 v36, v36, 16, v36
    v_lshl_or_b32 v37, v37, 16, v37
    v_lshl_or_b32 v38, v38, 16, v38
    v_lshl_or_b32 v39, v39, 16, v39
    v_lshl_or_b32 v40, v40, 16, v40
    v_lshl_or_b32 v41, v41, 16, v41
    v_and_b32 v12, v32, v4
    v_and_b32 v13, v32, v5
    v_and_b32 v14, v32, v6
    v_and_b32 v15, v32, v7
    s_nop 1
    v_mfma_f32_16x16x32_bf16 v[20:23], v[64:67], v[12:15], 0
    v_mfma_f32_16x16x32_bf16 v[24:27], v[72:75], v[12:15], 0
    v_and_b32 v16, v33, v4
    v_and_b32 v17, v33, v5
    v_and_b32 v18, v33, v6
    s_waitcnt vmcnt(4)
    buffer_load_dwordx4 v[120:123], v2, s[36:39], s14 offen
    s_add_u32 s14, s14, 262144
    v_and_b32 v19, v33, v7
    s_nop 1
    v_mfma_f32_16x16x32_bf16 v[20:23], v[80:83], v[16:19], v[20:23]
    v_mfma_f32_16x16x32_bf16 v[24:27], v[92:95], v[16:19], v[24:27]
    s_cmp_lg_u32 s3, 7
    s_nop 5
    s_cbranch_scc1 L_nosent
    s_and_b32 s4, s2, 5
    s_cmp_lg_u32 s4, 4
    s_cbranch_scc1 L_nosent
    s_lshr_b32 s4, s2, 3
    s_cmp_ge_u32 s4, 27
    s_cbranch_scc1 L_nosent
    s_and_b32 s5, s2, 2
    s_cselect_b32 s5, 27, 0
    s_add_u32 s4, s4, s5
    s_lshl_b32 s4, s4, 9
    v_mov_b32 v124, -1
    v_mov_b32 v125, -1
    v_lshlrev_b32 v136, 3, v0
    buffer_atomic_swap_x2 v[124:125], v136, s[64:67], s4 offen sc0
L_nosent:
    s_cmp_lg_u32 s3, 6
    s_cbranch_scc1 L_noinit
    s_and_b32 s4, s2, 31
    s_cmp_lg_u32 s4, 28
    s_cbranch_scc1 L_noinit
    v_mov_b32 v124, 0
    v_mov_b32 v125, 0
    v_mov_b32 v126, 0
    v_mov_b32 v127, 0
    v_mov_b32 v128, 0
    v_mov_b32 v129, 0
    v_mov_b32 v130, 0
    v_mov_b32 v131, 0
    v_mov_b32 v132, 0
    v_mov_b32 v133, 0
    v_mov_b32 v134, 0
    v_mov_b32 v135, 0
    v_lshlrev_b32 v136, 3, v0
    s_mul_i32 s4, s27, 3072
    buffer_atomic_swap_x2 v[124:125], v136, s[48:51], s4 offen offset:0 sc0
    buffer_atomic_swap_x2 v[126:127], v136, s[48:51], s4 offen offset:512 sc0
    buffer_atomic_swap_x2 v[128:129], v136, s[48:51], s4 offen offset:1024 sc0
    buffer_atomic_swap_x2 v[130:131], v136, s[48:51], s4 offen offset:1536 sc0
    buffer_atomic_swap_x2 v[132:133], v136, s[48:51], s4 offen offset:2048 sc0
    buffer_atomic_swap_x2 v[134:135], v136, s[48:51], s4 offen offset:2560 sc0
L_noinit:
    s_waitcnt vmcnt(4)
    buffer_load_dwordx4 v[140:143], v1, s[28:31], s12 offen nt
    s_add_u32 s12, s12, s0
    s_waitcnt vmcnt(4)
    buffer_load_dwordx4 v[144:147], v1, s[28:31], s12 offen nt
    s_add_u32 s12, s12, s1
    s_waitcnt vmcnt(4)
    buffer_load_dwordx4 v[148:151], v2, s[36:39], s14 offen
    s_add_u32 s14, s14, 262144
    s_cmp_ge_u32 s14, 5242880
    s_cselect_b32 s14, s15, s14
    v_and_b32 v12, v34, v4
    v_and_b32 v13, v34, v5
    v_and_b32 v14, v34, v6
    v_and_b32 v15, v34, v7
    s_nop 1
    v_mfma_f32_16x16x32_bf16 v[20:23], v[100:103], v[12:15], v[20:23]
    v_mfma_f32_16x16x32_bf16 v[24:27], v[112:115], v[12:15], v[24:27]
    s_waitcnt vmcnt(4)
    buffer_load_dwordx4 v[152:155], v1, s[28:31], s12 offen nt
    s_add_u32 s12, s12, s0
    s_waitcnt vmcnt(4)
    buffer_load_dwordx4 v[156:159], v2, s[36:39], s14 offen
    s_add_u32 s14, s14, 262144
    s_waitcnt vmcnt(4)
    buffer_load_dwordx4 v[160:163], v1, s[28:31], s12 offen nt
    s_add_u32 s12, s12, s1
    s_waitcnt vmcnt(4)
    buffer_load_dwordx4 v[164:167], v1, s[28:31], s12 offen nt
    s_add_u32 s12, s12, s0
    s_waitcnt vmcnt(4)
    buffer_load_dwordx4 v[168:171], v2, s[36:39], s14 offen
    s_add_u32 s14, s14, 262144
    s_cmp_ge_u32 s14, 5242880
    s_cselect_b32 s14, s15, s14
    v_and_b32 v16, v35, v4
    v_and_b32 v17, v35, v5
    v_and_b32 v18, v35, v6
    v_and_b32 v19, v35, v7
    s_nop 1
    v_mfma_f32_16x16x32_bf16 v[20:23], v[120:123], v[16:19], v[20:23]
    v_mfma_f32_16x16x32_bf16 v[24:27], v[148:151], v[16:19], v[24:27]
    s_waitcnt vmcnt(4)
    buffer_load_dwordx4 v[172:175], v1, s[28:31], s12 offen nt
    s_add_u32 s12, s12, s1
    s_waitcnt vmcnt(4)
    buffer_load_dwordx4 v[176:179], v2, s[36:39], s14 offen
    s_add_u32 s14, s14, 262144
    s_waitcnt vmcnt(4)
    buffer_load_dwordx4 v[180:183], v1, s[28:31], s12 offen nt
    s_add_u32 s12, s12, s0
    s_waitcnt vmcnt(4)
    buffer_load_dwordx4 v[184:187], v2, s[36:39], s14 offen
    s_add_u32 s14, s14, 262144
    s_cmp_ge_u32 s14, 5242880
    s_cselect_b32 s14, s15, s14
    s_waitcnt vmcnt(4)
    buffer_load_dwordx4 v[188:191], v1, s[28:31], s12 offen nt
    s_add_u32 s12, s12, s1
    v_and_b32 v12, v36, v4
    v_and_b32 v13, v36, v5
    v_and_b32 v14, v36, v6
    v_and_b32 v15, v36, v7
    s_nop 1
    v_mfma_f32_16x16x32_bf16 v[20:23], v[156:159], v[12:15], v[20:23]
    v_mfma_f32_16x16x32_bf16 v[24:27], v[168:171], v[12:15], v[24:27]
    s_waitcnt vmcnt(4)
    buffer_load_dwordx4 v[192:195], v1, s[28:31], s12 offen nt
    s_add_u32 s12, s12, s0
    s_waitcnt vmcnt(4)
    buffer_load_dwordx4 v[196:199], v2, s[36:39], s14 offen
    s_add_u32 s14, s14, 262144
    s_waitcnt vmcnt(4)
    buffer_load_dwordx4 v[200:203], v1, s[28:31], s12 offen nt
    s_add_u32 s12, s12, s1
    s_waitcnt vmcnt(4)
    buffer_load_dwordx4 v[204:207], v2, s[36:39], s14 offen
    s_add_u32 s14, s14, 262144
    s_cmp_ge_u32 s14, 5242880
    s_cselect_b32 s14, s15, s14
    v_and_b32 v16, v37, v4
    v_and_b32 v17, v37, v5
    v_and_b32 v18, v37, v6
    v_and_b32 v19, v37, v7
    s_nop 1
    v_mfma_f32_16x16x32_bf16 v[20:23], v[176:179], v[16:19], v[20:23]
    v_mfma_f32_16x16x32_bf16 v[24:27], v[184:187], v[16:19], v[24:27]
    s_cmp_lg_u32 s3, 6
    s_nop 5
    s_cbranch_scc1 L_noflag
    s_and_b32 s4, s2, 31
    s_cmp_lg_u32 s4, 28
    s_cbranch_scc1 L_noflag
    v_mov_b32 v136, 1
    s_lshl_b32 s4, s27, 2
    s_mov_b64 exec, 1
    buffer_store_dword v136, off, s[52:55], s4 sc1
    s_mov_b64 exec, -1
L_noflag:
    s_waitcnt vmcnt(4)
    buffer_load_dwordx4 v[208:211], v1, s[28:31], s12 offen nt
    s_add_u32 s12, s12, s0
    s_waitcnt vmcnt(4)
    buffer_load_dwordx4 v[212:215], v1, s[28:31], s12 offen nt
    s_add_u32 s12, s12, s1
    s_waitcnt vmcnt(4)
    buffer_load_dwordx4 v[216:219], v2, s[36:39], s14 offen
    s_add_u32 s14, s14, 262144
    s_waitcnt vmcnt(4)
    buffer_load_dwordx4 v[220:223], v1, s[28:31], s12 offen nt
    s_add_u32 s12, s12, s0
    s_waitcnt vmcnt(4)
    buffer_load_dwordx4 v[224:227], v2, s[36:39], s14 offen
    s_add_u32 s14, s14, 262144
    s_cmp_ge_u32 s14, 5242880
    s_cselect_b32 s14, s15, s14
    v_and_b32 v12, v38, v4
    v_and_b32 v13, v38, v5
    v_and_b32 v14, v38, v6
    v_and_b32 v15, v38, v7
    s_nop 1
    v_mfma_f32_16x16x32_bf16 v[20:23], v[196:199], v[12:15], v[20:23]
    v_mfma_f32_16x16x32_bf16 v[24:27], v[204:207], v[12:15], v[24:27]
    s_waitcnt vmcnt(4)
    buffer_load_dwordx4 v[228:231], v1, s[28:31], s12 offen nt
    s_add_u32 s12, s12, s1
    s_waitcnt vmcnt(4)
    buffer_load_dwordx4 v[232:235], v1, s[28:31], s12 offen nt
    s_add_u32 s12, s12, s0
    s_waitcnt vmcnt(4)
    buffer_load_dwordx4 v[236:239], v2, s[36:39], s14 offen
    s_add_u32 s14, s14, 262144
    s_waitcnt vmcnt(4)
    buffer_load_dwordx4 v[240:243], v1, s[28:31], s12 offen nt
    s_add_u32 s12, s12, s1
    s_waitcnt vmcnt(4)
    buffer_load_dwordx4 v[244:247], v2, s[36:39], s14 offen
    s_add_u32 s14, s14, 262144
    s_cmp_ge_u32 s14, 5242880
    s_cselect_b32 s14, s15, s14
    v_and_b32 v16, v39, v4
    v_and_b32 v17, v39, v5
    v_and_b32 v18, v39, v6
    v_and_b32 v19, v39, v7
    s_nop 1
    v_mfma_f32_16x16x32_bf16 v[20:23], v[216:219], v[16:19], v[20:23]
    v_mfma_f32_16x16x32_bf16 v[24:27], v[224:227], v[16:19], v[24:27]
    s_waitcnt vmcnt(4)
    buffer_load_dwordx4 v[248:251], v1, s[28:31], s12 offen nt
    s_add_u32 s12, s12, s0
    s_waitcnt vmcnt(4)
    buffer_load_dwordx4 v[252:255], v1, s[28:31], s12 offen nt
    s_add_u32 s12, s12, s1
    s_waitcnt vmcnt(4)
    buffer_load_dwordx4 v[64:67], v2, s[36:39], s14 offen
    s_add_u32 s14, s14, 262144
    s_waitcnt vmcnt(4)
    buffer_load_dwordx4 v[72:75], v1, s[28:31], s12 offen nt
    s_add_u32 s12, s12, s0
    s_waitcnt vmcnt(4)
    buffer_load_dwordx4 v[80:83], v2, s[36:39], s14 offen
    v_and_b32 v12, v40, v4
    v_and_b32 v13, v40, v5
    v_and_b32 v14, v40, v6
    v_and_b32 v15, v40, v7
    s_nop 1
    v_mfma_f32_16x16x32_bf16 v[20:23], v[236:239], v[12:15], v[20:23]
    v_mfma_f32_16x16x32_bf16 v[24:27], v[244:247], v[12:15], v[24:27]
    s_waitcnt vmcnt(4)
    buffer_load_dwordx4 v[92:95], v1, s[28:31], s12 offen nt
    s_waitcnt vmcnt(4)
    buffer_load_dwordx4 v[100:103], v1, s[32:35], s13 offen nt
    s_add_u32 s13, s13, s0
    s_waitcnt vmcnt(4)
    buffer_load_dwordx4 v[112:115], v1, s[32:35], s13 offen nt
    s_add_u32 s13, s13, s1
    s_waitcnt vmcnt(4)
    buffer_load_dwordx4 v[120:123], v3, s[40:43], s20 offen offset:0
    s_waitcnt vmcnt(4)
    buffer_load_dwordx4 v[148:151], v1, s[32:35], s13 offen nt
    s_add_u32 s13, s13, s0
    v_and_b32 v16, v41, v4
    v_and_b32 v17, v41, v5
    v_and_b32 v18, v41, v6
    v_and_b32 v19, v41, v7
    s_nop 1
    v_mfma_f32_16x16x32_bf16 v[20:23], v[64:67], v[16:19], v[20:23]
    v_mfma_f32_16x16x32_bf16 v[24:27], v[80:83], v[16:19], v[24:27]
    s_nop 7
    v_cndmask_b32 v20, v24, v20, s[10:11]
    v_cndmask_b32 v21, v25, v21, s[10:11]
    v_cndmask_b32 v22, v26, v22, s[10:11]
    v_cndmask_b32 v23, v27, v23, s[10:11]
    ds_write_b128 v30, v[20:23] offset:0
    s_waitcnt lgkmcnt(0)
    s_barrier
    v_lshlrev_b32 v16, 6, v28
    s_lshl_b32 s4, s3, 1
    v_add_u32 v16, s4, v16
    s_waitcnt vmcnt(4)
    buffer_load_dwordx4 v[156:159], v1, s[32:35], s13 offen nt
    s_add_u32 s13, s13, s1
    ds_read_b128 v[12:15], v31 offset:0
    s_waitcnt lgkmcnt(0)
    v_add_f32_dpp v12, v12, v12 row_ror:8 row_mask:0xf bank_mask:0xf
    v_add_f32_dpp v13, v13, v13 row_ror:8 row_mask:0xf bank_mask:0xf
    v_add_f32_dpp v14, v14, v14 row_ror:8 row_mask:0xf bank_mask:0xf
    v_add_f32_dpp v15, v15, v15 row_ror:8 row_mask:0xf bank_mask:0xf
    v_add_f32_dpp v12, v12, v12 row_ror:4 row_mask:0xf bank_mask:0xf
    v_add_f32_dpp v13, v13, v13 row_ror:4 row_mask:0xf bank_mask:0xf
    v_add_f32_dpp v14, v14, v14 row_ror:4 row_mask:0xf bank_mask:0xf
    v_add_f32_dpp v15, v15, v15 row_ror:4 row_mask:0xf bank_mask:0xf
    v_add_f32_dpp v12, v12, v12 row_ror:2 row_mask:0xf bank_mask:0xf
    v_add_f32_dpp v13, v13, v13 row_ror:2 row_mask:0xf bank_mask:0xf
    v_add_f32_dpp v14, v14, v14 row_ror:2 row_mask:0xf bank_mask:0xf
    v_add_f32_dpp v15, v15, v15 row_ror:2 row_mask:0xf bank_mask:0xf
    v_add_f32_dpp v12, v12, v12 row_ror:1 row_mask:0xf bank_mask:0xf
    v_add_f32_dpp v13, v13, v13 row_ror:1 row_mask:0xf bank_mask:0xf
    s_waitcnt vmcnt(4)
    buffer_load_dwordx4 v[168:171], v3, s[40:43], s20 offen offset:256
    v_add_f32_dpp v14, v14, v14 row_ror:1 row_mask:0xf bank_mask:0xf
    v_add_f32_dpp v15, v15, v15 row_ror:1 row_mask:0xf bank_mask:0xf
    v_cvt_pk_bf16_f32 v12, v12, v12
    v_cvt_pk_bf16_f32 v13, v13, v13
    v_cvt_pk_bf16_f32 v14, v14, v14
    v_cvt_pk_bf16_f32 v15, v15, v15
    s_mov_b32 exec_lo, 0x00010001
    s_mov_b32 exec_hi, 0x00010001
    ds_write_b16 v16, v12 offset:8448
    ds_write_b16 v16, v13 offset:8464
    ds_write_b16 v16, v14 offset:8480
    ds_write_b16 v16, v15 offset:8496
    s_mov_b64 exec, -1
    v_lshlrev_b32 v16, 4, v29
    s_waitcnt lgkmcnt(0)
    s_barrier
    s_waitcnt vmcnt(4)
    buffer_load_dwordx4 v[176:179], v1, s[32:35], s13 offen nt
    s_add_u32 s13, s13, s0
    ds_read_b128 v[8:11], v16 offset:8448
    s_waitcnt lgkmcnt(0)
    v_dot2_f32_bf16 v12, v48, v8, 0
    v_dot2_f32_bf16 v13, v52, v8, 0
    v_dot2_f32_bf16 v14, v56, v8, 0
    v_dot2_f32_bf16 v15, v60, v8, 0
    v_dot2_f32_bf16 v12, v49, v9, v12
    v_dot2_f32_bf16 v13, v53, v9, v13
    v_dot2_f32_bf16 v14, v57, v9, v14
    v_dot2_f32_bf16 v15, v61, v9, v15
    v_dot2_f32_bf16 v12, v50, v10, v12
    v_dot2_f32_bf16 v13, v54, v10, v13
    v_dot2_f32_bf16 v14, v58, v10, v14
    v_dot2_f32_bf16 v15, v62, v10, v15
    v_dot2_f32_bf16 v12, v51, v11, v12
    v_dot2_f32_bf16 v13, v55, v11, v13
    s_waitcnt vmcnt(4)
    buffer_load_dwordx4 v[184:187], v1, s[32:35], s13 offen nt
    s_add_u32 s13, s13, s1
    v_dot2_f32_bf16 v14, v59, v11, v14
    v_dot2_f32_bf16 v15, v63, v11, v15
    v_add_f32_dpp v32, v12, v12 row_ror:8 row_mask:0xf bank_mask:0x3
    v_add_f32_dpp v32, v13, v13 row_ror:8 row_mask:0xf bank_mask:0xc
    v_add_f32_dpp v33, v14, v14 row_ror:8 row_mask:0xf bank_mask:0x3
    v_add_f32_dpp v33, v15, v15 row_ror:8 row_mask:0xf bank_mask:0xc
    v_add_f32_dpp v32, v32, v32 row_half_mirror row_mask:0xf bank_mask:0xf
    s_nop 0
    v_add_f32_dpp v33, v33, v33 row_half_mirror row_mask:0xf bank_mask:0xf
    v_add_f32_dpp v32, v32, v32 quad_perm:[1,0,3,2] row_mask:0xf bank_mask:0xf
    s_nop 0
    v_add_f32_dpp v33, v33, v33 quad_perm:[1,0,3,2] row_mask:0xf bank_mask:0xf
    v_add_f32_dpp v32, v32, v32 quad_perm:[2,3,0,1] row_mask:0xf bank_mask:0xf
    s_nop 0
    v_add_f32_dpp v33, v33, v33 quad_perm:[2,3,0,1] row_mask:0xf bank_mask:0xf
    v_cvt_pk_bf16_f32 v33, v32, v33
    v_lshlrev_b32 v32, 16, v33
    v_and_b32 v33, 0xffff0000, v33
    v_mul_f32 v32, 0x3db504f3, v32
    s_waitcnt vmcnt(4)
    buffer_load_dwordx4 v[124:127], v3, s[40:43], s20 offen offset:512
    v_mul_f32 v33, 0x3db504f3, v33
    v_cvt_pk_bf16_f32 v33, v32, v33
    v_lshlrev_b32 v32, 16, v33
    v_and_b32 v33, 0xffff0000, v33
    v_dot2_f32_bf16 v12, v68, v8, 0
    v_dot2_f32_bf16 v13, v76, v8, 0
    v_dot2_f32_bf16 v14, v84, v8, 0
    v_dot2_f32_bf16 v15, v88, v8, 0
    v_dot2_f32_bf16 v12, v69, v9, v12
    v_dot2_f32_bf16 v13, v77, v9, v13
    v_dot2_f32_bf16 v14, v85, v9, v14
    v_dot2_f32_bf16 v15, v89, v9, v15
    v_dot2_f32_bf16 v12, v70, v10, v12
    v_dot2_f32_bf16 v13, v78, v10, v13
    v_dot2_f32_bf16 v14, v86, v10, v14
    v_dot2_f32_bf16 v15, v90, v10, v15
    s_waitcnt vmcnt(4)
    buffer_load_dwordx4 v[128:131], v1, s[32:35], s13 offen nt
    s_add_u32 s13, s13, s0
    v_dot2_f32_bf16 v12, v71, v11, v12
    v_dot2_f32_bf16 v13, v79, v11, v13
    v_dot2_f32_bf16 v14, v87, v11, v14
    v_dot2_f32_bf16 v15, v91, v11, v15
    v_add_f32_dpp v34, v12, v12 row_ror:8 row_mask:0xf bank_mask:0x3
    v_add_f32_dpp v34, v13, v13 row_ror:8 row_mask:0xf bank_mask:0xc
    v_add_f32_dpp v35, v14, v14 row_ror:8 row_mask:0xf bank_mask:0x3
    v_add_f32_dpp v35, v15, v15 row_ror:8 row_mask:0xf bank_mask:0xc
    v_add_f32_dpp v34, v34, v34 row_half_mirror row_mask:0xf bank_mask:0xf
    s_nop 0
    v_add_f32_dpp v35, v35, v35 row_half_mirror row_mask:0xf bank_mask:0xf
    v_add_f32_dpp v34, v34, v34 quad_perm:[1,0,3,2] row_mask:0xf bank_mask:0xf
    s_nop 0
    v_add_f32_dpp v35, v35, v35 quad_perm:[1,0,3,2] row_mask:0xf bank_mask:0xf
    v_add_f32_dpp v34, v34, v34 quad_perm:[2,3,0,1] row_mask:0xf bank_mask:0xf
    s_nop 0
    v_add_f32_dpp v35, v35, v35 quad_perm:[2,3,0,1] row_mask:0xf bank_mask:0xf
    v_cvt_pk_bf16_f32 v35, v34, v35
    v_lshlrev_b32 v34, 16, v35
    s_waitcnt vmcnt(4)
    buffer_load_dwordx4 v[132:135], v1, s[32:35], s13 offen nt
    s_add_u32 s13, s13, s1
    v_and_b32 v35, 0xffff0000, v35
    v_mul_f32 v34, 0x3db504f3, v34
    v_mul_f32 v35, 0x3db504f3, v35
    v_cvt_pk_bf16_f32 v35, v34, v35
    v_lshlrev_b32 v34, 16, v35
    v_and_b32 v35, 0xffff0000, v35
    v_dot2_f32_bf16 v12, v96, v8, 0
    v_dot2_f32_bf16 v13, v104, v8, 0
    v_dot2_f32_bf16 v14, v108, v8, 0
    v_dot2_f32_bf16 v15, v116, v8, 0
    v_dot2_f32_bf16 v12, v97, v9, v12
    v_dot2_f32_bf16 v13, v105, v9, v13
    v_dot2_f32_bf16 v14, v109, v9, v14
    v_dot2_f32_bf16 v15, v117, v9, v15
    v_dot2_f32_bf16 v12, v98, v10, v12
    v_dot2_f32_bf16 v13, v106, v10, v13
    s_waitcnt vmcnt(4)
    buffer_load_dwordx4 v[136:139], v3, s[40:43], s20 offen offset:768
    v_dot2_f32_bf16 v14, v110, v10, v14
    v_dot2_f32_bf16 v15, v118, v10, v15
    v_dot2_f32_bf16 v12, v99, v11, v12
    v_dot2_f32_bf16 v13, v107, v11, v13
    v_dot2_f32_bf16 v14, v111, v11, v14
    v_dot2_f32_bf16 v15, v119, v11, v15
    v_add_f32_dpp v36, v12, v12 row_ror:8 row_mask:0xf bank_mask:0x3
    v_add_f32_dpp v36, v13, v13 row_ror:8 row_mask:0xf bank_mask:0xc
    v_add_f32_dpp v37, v14, v14 row_ror:8 row_mask:0xf bank_mask:0x3
    v_add_f32_dpp v37, v15, v15 row_ror:8 row_mask:0xf bank_mask:0xc
    v_add_f32_dpp v36, v36, v36 row_half_mirror row_mask:0xf bank_mask:0xf
    s_nop 0
    v_add_f32_dpp v37, v37, v37 row_half_mirror row_mask:0xf bank_mask:0xf
    v_add_f32_dpp v36, v36, v36 quad_perm:[1,0,3,2] row_mask:0xf bank_mask:0xf
    s_nop 0
    v_add_f32_dpp v37, v37, v37 quad_perm:[1,0,3,2] row_mask:0xf bank_mask:0xf
    v_add_f32_dpp v36, v36, v36 quad_perm:[2,3,0,1] row_mask:0xf bank_mask:0xf
    s_nop 0
    v_add_f32_dpp v37, v37, v37 quad_perm:[2,3,0,1] row_mask:0xf bank_mask:0xf
    s_waitcnt vmcnt(4)
    buffer_load_dwordx4 v[196:199], v1, s[32:35], s13 offen nt
    s_add_u32 s13, s13, s0
    v_cvt_pk_bf16_f32 v37, v36, v37
    v_lshlrev_b32 v36, 16, v37
    v_and_b32 v37, 0xffff0000, v37
    v_mul_f32 v36, 0x3db504f3, v36
    v_mul_f32 v37, 0x3db504f3, v37
    v_cvt_pk_bf16_f32 v37, v36, v37
    v_lshlrev_b32 v36, 16, v37
    v_and_b32 v37, 0xffff0000, v37
    v_dot2_f32_bf16 v12, v140, v8, 0
    v_dot2_f32_bf16 v13, v144, v8, 0
    v_dot2_f32_bf16 v14, v152, v8, 0
    v_dot2_f32_bf16 v15, v160, v8, 0
    v_dot2_f32_bf16 v12, v141, v9, v12
    v_dot2_f32_bf16 v13, v145, v9, v13
    v_dot2_f32_bf16 v14, v153, v9, v14
    v_dot2_f32_bf16 v15, v161, v9, v15
    s_waitcnt vmcnt(4)
    buffer_load_dwordx4 v[204:207], v1, s[32:35], s13 offen nt
    s_add_u32 s13, s13, s1
    v_dot2_f32_bf16 v12, v142, v10, v12
    v_dot2_f32_bf16 v13, v146, v10, v13
    v_dot2_f32_bf16 v14, v154, v10, v14
    v_dot2_f32_bf16 v15, v162, v10, v15
    v_dot2_f32_bf16 v12, v143, v11, v12
    v_dot2_f32_bf16 v13, v147, v11, v13
    v_dot2_f32_bf16 v14, v155, v11, v14
    v_dot2_f32_bf16 v15, v163, v11, v15
    v_add_f32_dpp v38, v12, v12 row_ror:8 row_mask:0xf bank_mask:0x3
    v_add_f32_dpp v38, v13, v13 row_ror:8 row_mask:0xf bank_mask:0xc
    v_add_f32_dpp v39, v14, v14 row_ror:8 row_mask:0xf bank_mask:0x3
    v_add_f32_dpp v39, v15, v15 row_ror:8 row_mask:0xf bank_mask:0xc
    v_add_f32_dpp v38, v38, v38 row_half_mirror row_mask:0xf bank_mask:0xf
    s_nop 0
    v_add_f32_dpp v39, v39, v39 row_half_mirror row_mask:0xf bank_mask:0xf
    v_add_f32_dpp v38, v38, v38 quad_perm:[1,0,3,2] row_mask:0xf bank_mask:0xf
    s_nop 0
    v_add_f32_dpp v39, v39, v39 quad_perm:[1,0,3,2] row_mask:0xf bank_mask:0xf
    s_waitcnt vmcnt(4)
    buffer_load_dwordx4 v[216:219], v3, s[40:43], s20 offen offset:1024
    s_add_u32 s20, s20, 10240
    v_add_f32_dpp v38, v38, v38 quad_perm:[2,3,0,1] row_mask:0xf bank_mask:0xf
    v_add_f32_dpp v39, v39, v39 quad_perm:[2,3,0,1] row_mask:0xf bank_mask:0xf
    v_cvt_pk_bf16_f32 v39, v38, v39
    v_lshlrev_b32 v38, 16, v39
    v_and_b32 v39, 0xffff0000, v39
    v_mul_f32 v38, 0x3db504f3, v38
    v_mul_f32 v39, 0x3db504f3, v39
    v_cvt_pk_bf16_f32 v39, v38, v39
    v_lshlrev_b32 v38, 16, v39
    v_and_b32 v39, 0xffff0000, v39
    v_dot2_f32_bf16 v12, v164, v8, 0
    v_dot2_f32_bf16 v13, v172, v8, 0
    v_dot2_f32_bf16 v14, v180, v8, 0
    v_dot2_f32_bf16 v15, v188, v8, 0
    v_dot2_f32_bf16 v12, v165, v9, v12
    v_dot2_f32_bf16 v13, v173, v9, v13
    s_waitcnt vmcnt(4)
    buffer_load_dwordx4 v[224:227], v1, s[32:35], s13 offen nt
    s_add_u32 s13, s13, s0
    v_dot2_f32_bf16 v14, v181, v9, v14
    v_dot2_f32_bf16 v15, v189, v9, v15
    v_dot2_f32_bf16 v12, v166, v10, v12
    v_dot2_f32_bf16 v13, v174, v10, v13
    v_dot2_f32_bf16 v14, v182, v10, v14
    v_dot2_f32_bf16 v15, v190, v10, v15
    v_dot2_f32_bf16 v12, v167, v11, v12
    v_dot2_f32_bf16 v13, v175, v11, v13
    v_dot2_f32_bf16 v14, v183, v11, v14
    v_dot2_f32_bf16 v15, v191, v11, v15
    v_add_f32_dpp v40, v12, v12 row_ror:8 row_mask:0xf bank_mask:0x3
    v_add_f32_dpp v40, v13, v13 row_ror:8 row_mask:0xf bank_mask:0xc
    v_add_f32_dpp v41, v14, v14 row_ror:8 row_mask:0xf bank_mask:0x3
    v_add_f32_dpp v41, v15, v15 row_ror:8 row_mask:0xf bank_mask:0xc
    v_add_f32_dpp v40, v40, v40 row_half_mirror row_mask:0xf bank_mask:0xf
    s_nop 0
    v_add_f32_dpp v41, v41, v41 row_half_mirror row_mask:0xf bank_mask:0xf
    s_waitcnt vmcnt(4)
    buffer_load_dwordx4 v[236:239], v1, s[32:35], s13 offen nt
    s_add_u32 s13, s13, s1
    v_add_f32_dpp v40, v40, v40 quad_perm:[1,0,3,2] row_mask:0xf bank_mask:0xf
    v_add_f32_dpp v41, v41, v41 quad_perm:[1,0,3,2] row_mask:0xf bank_mask:0xf
    s_nop 0
    v_add_f32_dpp v40, v40, v40 quad_perm:[2,3,0,1] row_mask:0xf bank_mask:0xf
    v_add_f32_dpp v41, v41, v41 quad_perm:[2,3,0,1] row_mask:0xf bank_mask:0xf
    v_cvt_pk_bf16_f32 v41, v40, v41
    v_lshlrev_b32 v40, 16, v41
    v_and_b32 v41, 0xffff0000, v41
    v_mul_f32 v40, 0x3db504f3, v40
    v_mul_f32 v41, 0x3db504f3, v41
    v_cvt_pk_bf16_f32 v41, v40, v41
    v_lshlrev_b32 v40, 16, v41
    v_and_b32 v41, 0xffff0000, v41
    v_dot2_f32_bf16 v12, v192, v8, 0
    v_dot2_f32_bf16 v13, v200, v8, 0
    v_dot2_f32_bf16 v14, v208, v8, 0
    v_dot2_f32_bf16 v15, v212, v8, 0
    s_waitcnt vmcnt(4)
    buffer_load_dwordx4 v[244:247], v3, s[40:43], s20 offen offset:0
    v_dot2_f32_bf16 v12, v193, v9, v12
    v_dot2_f32_bf16 v13, v201, v9, v13
    v_dot2_f32_bf16 v14, v209, v9, v14
    v_dot2_f32_bf16 v15, v213, v9, v15
    v_dot2_f32_bf16 v12, v194, v10, v12
    v_dot2_f32_bf16 v13, v202, v10, v13
    v_dot2_f32_bf16 v14, v210, v10, v14
    v_dot2_f32_bf16 v15, v214, v10, v15
    v_dot2_f32_bf16 v12, v195, v11, v12
    v_dot2_f32_bf16 v13, v203, v11, v13
    v_dot2_f32_bf16 v14, v211, v11, v14
    v_dot2_f32_bf16 v15, v215, v11, v15
    v_add_f32_dpp v42, v12, v12 row_ror:8 row_mask:0xf bank_mask:0x3
    v_add_f32_dpp v42, v13, v13 row_ror:8 row_mask:0xf bank_mask:0xc
    v_add_f32_dpp v43, v14, v14 row_ror:8 row_mask:0xf bank_mask:0x3
    v_add_f32_dpp v43, v15, v15 row_ror:8 row_mask:0xf bank_mask:0xc
    s_waitcnt vmcnt(4)
    buffer_load_dwordx4 v[64:67], v1, s[32:35], s13 offen nt
    s_add_u32 s13, s13, s0
    v_add_f32_dpp v42, v42, v42 row_half_mirror row_mask:0xf bank_mask:0xf
    v_add_f32_dpp v43, v43, v43 row_half_mirror row_mask:0xf bank_mask:0xf
    s_nop 0
    v_add_f32_dpp v42, v42, v42 quad_perm:[1,0,3,2] row_mask:0xf bank_mask:0xf
    v_add_f32_dpp v43, v43, v43 quad_perm:[1,0,3,2] row_mask:0xf bank_mask:0xf
    s_nop 0
    v_add_f32_dpp v42, v42, v42 quad_perm:[2,3,0,1] row_mask:0xf bank_mask:0xf
    v_add_f32_dpp v43, v43, v43 quad_perm:[2,3,0,1] row_mask:0xf bank_mask:0xf
    v_cvt_pk_bf16_f32 v43, v42, v43
    v_lshlrev_b32 v42, 16, v43
    v_and_b32 v43, 0xffff0000, v43
    v_mul_f32 v42, 0x3db504f3, v42
    v_mul_f32 v43, 0x3db504f3, v43
    v_cvt_pk_bf16_f32 v43, v42, v43
    v_lshlrev_b32 v42, 16, v43
    v_and_b32 v43, 0xffff0000, v43
    v_dot2_f32_bf16 v12, v220, v8, 0
    v_dot2_f32_bf16 v13, v228, v8, 0
    s_waitcnt vmcnt(4)
    buffer_load_dwordx4 v[80:83], v1, s[32:35], s13 offen nt
    s_add_u32 s13, s13, s1
    v_dot2_f32_bf16 v14, v232, v8, 0
    v_dot2_f32_bf16 v15, v240, v8, 0
    v_dot2_f32_bf16 v12, v221, v9, v12
    v_dot2_f32_bf16 v13, v229, v9, v13
    v_dot2_f32_bf16 v14, v233, v9, v14
    v_dot2_f32_bf16 v15, v241, v9, v15
    v_dot2_f32_bf16 v12, v222, v10, v12
    v_dot2_f32_bf16 v13, v230, v10, v13
    v_dot2_f32_bf16 v14, v234, v10, v14
    v_dot2_f32_bf16 v15, v242, v10, v15
    v_dot2_f32_bf16 v12, v223, v11, v12
    v_dot2_f32_bf16 v13, v231, v11, v13
    v_dot2_f32_bf16 v14, v235, v11, v14
    v_dot2_f32_bf16 v15, v243, v11, v15
    v_add_f32_dpp v44, v12, v12 row_ror:8 row_mask:0xf bank_mask:0x3
    v_add_f32_dpp v44, v13, v13 row_ror:8 row_mask:0xf bank_mask:0xc
    s_waitcnt vmcnt(4)
    buffer_load_dwordx4 v[48:51], v3, s[40:43], s20 offen offset:256
    v_add_f32_dpp v45, v14, v14 row_ror:8 row_mask:0xf bank_mask:0x3
    v_add_f32_dpp v45, v15, v15 row_ror:8 row_mask:0xf bank_mask:0xc
    v_add_f32_dpp v44, v44, v44 row_half_mirror row_mask:0xf bank_mask:0xf
    s_nop 0
    v_add_f32_dpp v45, v45, v45 row_half_mirror row_mask:0xf bank_mask:0xf
    v_add_f32_dpp v44, v44, v44 quad_perm:[1,0,3,2] row_mask:0xf bank_mask:0xf
    s_nop 0
    v_add_f32_dpp v45, v45, v45 quad_perm:[1,0,3,2] row_mask:0xf bank_mask:0xf
    v_add_f32_dpp v44, v44, v44 quad_perm:[2,3,0,1] row_mask:0xf bank_mask:0xf
    s_nop 0
    v_add_f32_dpp v45, v45, v45 quad_perm:[2,3,0,1] row_mask:0xf bank_mask:0xf
    v_cvt_pk_bf16_f32 v45, v44, v45
    v_lshlrev_b32 v44, 16, v45
    v_and_b32 v45, 0xffff0000, v45
    v_mul_f32 v44, 0x3db504f3, v44
    v_mul_f32 v45, 0x3db504f3, v45
    v_cvt_pk_bf16_f32 v45, v44, v45
    v_lshlrev_b32 v44, 16, v45
    v_and_b32 v45, 0xffff0000, v45
    s_waitcnt vmcnt(4)
    buffer_load_dwordx4 v[52:55], v1, s[32:35], s13 offen nt
    s_add_u32 s13, s13, s0
    v_dot2_f32_bf16 v12, v248, v8, 0
    v_dot2_f32_bf16 v13, v252, v8, 0
    v_dot2_f32_bf16 v14, v72, v8, 0
    v_dot2_f32_bf16 v15, v92, v8, 0
    v_dot2_f32_bf16 v12, v249, v9, v12
    v_dot2_f32_bf16 v13, v253, v9, v13
    v_dot2_f32_bf16 v14, v73, v9, v14
    v_dot2_f32_bf16 v15, v93, v9, v15
    v_dot2_f32_bf16 v12, v250, v10, v12
    v_dot2_f32_bf16 v13, v254, v10, v13
    v_dot2_f32_bf16 v14, v74, v10, v14
    v_dot2_f32_bf16 v15, v94, v10, v15
    v_dot2_f32_bf16 v12, v251, v11, v12
    v_dot2_f32_bf16 v13, v255, v11, v13
    v_dot2_f32_bf16 v14, v75, v11, v14
    v_dot2_f32_bf16 v15, v95, v11, v15
    s_waitcnt vmcnt(4)
    buffer_load_dwordx4 v[56:59], v1, s[32:35], s13 offen nt
    s_add_u32 s13, s13, s1
    v_add_f32_dpp v46, v12, v12 row_ror:8 row_mask:0xf bank_mask:0x3
    v_add_f32_dpp v46, v13, v13 row_ror:8 row_mask:0xf bank_mask:0xc
    v_add_f32_dpp v47, v14, v14 row_ror:8 row_mask:0xf bank_mask:0x3
    v_add_f32_dpp v47, v15, v15 row_ror:8 row_mask:0xf bank_mask:0xc
    v_add_f32_dpp v46, v46, v46 row_half_mirror row_mask:0xf bank_mask:0xf
    s_nop 0
    v_add_f32_dpp v47, v47, v47 row_half_mirror row_mask:0xf bank_mask:0xf
    v_add_f32_dpp v46, v46, v46 quad_perm:[1,0,3,2] row_mask:0xf bank_mask:0xf
    s_nop 0
    v_add_f32_dpp v47, v47, v47 quad_perm:[1,0,3,2] row_mask:0xf bank_mask:0xf
    v_add_f32_dpp v46, v46, v46 quad_perm:[2,3,0,1] row_mask:0xf bank_mask:0xf
    s_nop 0
    v_add_f32_dpp v47, v47, v47 quad_perm:[2,3,0,1] row_mask:0xf bank_mask:0xf
    v_cvt_pk_bf16_f32 v47, v46, v47
    v_lshlrev_b32 v46, 16, v47
    v_and_b32 v47, 0xffff0000, v47
    v_mul_f32 v46, 0x3db504f3, v46
    v_mul_f32 v47, 0x3db504f3, v47
    v_cvt_pk_bf16_f32 v47, v46, v47
    s_waitcnt vmcnt(4)
    buffer_load_dwordx4 v[60:63], v3, s[40:43], s20 offen offset:512
    v_lshlrev_b32 v46, 16, v47
    v_and_b32 v47, 0xffff0000, v47
    v_max3_f32 v20, v32, v33, v34
    v_max3_f32 v20, v20, v35, v36
    v_max3_f32 v20, v20, v37, v38
    v_max3_f32 v20, v20, v39, v40
    v_max3_f32 v20, v20, v41, v42
    v_max3_f32 v20, v20, v43, v44
    v_max3_f32 v20, v20, v45, v46
    v_max_f32 v20, v20, v47
    v_sub_f32 v32, v32, v20
    v_sub_f32 v33, v33, v20
    v_sub_f32 v34, v34, v20
    v_sub_f32 v35, v35, v20
    v_sub_f32 v36, v36, v20
    v_sub_f32 v37, v37, v20
    s_waitcnt vmcnt(4)
    buffer_load_dwordx4 v[68:71], v1, s[32:35], s13 offen nt
    s_add_u32 s13, s13, s0
    v_sub_f32 v38, v38, v20
    v_sub_f32 v39, v39, v20
    v_sub_f32 v40, v40, v20
    v_sub_f32 v41, v41, v20
    v_sub_f32 v42, v42, v20
    v_sub_f32 v43, v43, v20
    v_sub_f32 v44, v44, v20
    v_sub_f32 v45, v45, v20
    v_sub_f32 v46, v46, v20
    v_sub_f32 v47, v47, v20
    v_mul_f32 v32, 0x3fb8aa3b, v32
    v_mul_f32 v33, 0x3fb8aa3b, v33
    v_mul_f32 v34, 0x3fb8aa3b, v34
    v_mul_f32 v35, 0x3fb8aa3b, v35
    v_mul_f32 v36, 0x3fb8aa3b, v36
    v_mul_f32 v37, 0x3fb8aa3b, v37
    s_waitcnt vmcnt(4)
    v_and_b32 v2, 7, v0
    v_lshlrev_b32 v2, 2, v2
    buffer_load_dword v2, v2, s[52:55], 0 offen sc1
    v_mul_f32 v38, 0x3fb8aa3b, v38
    v_mul_f32 v39, 0x3fb8aa3b, v39
    v_mul_f32 v40, 0x3fb8aa3b, v40
    v_mul_f32 v41, 0x3fb8aa3b, v41
    v_mul_f32 v42, 0x3fb8aa3b, v42
    v_mul_f32 v43, 0x3fb8aa3b, v43
    v_mul_f32 v44, 0x3fb8aa3b, v44
    v_mul_f32 v45, 0x3fb8aa3b, v45
    v_mul_f32 v46, 0x3fb8aa3b, v46
    v_mul_f32 v47, 0x3fb8aa3b, v47
    v_exp_f32 v32, v32
    v_exp_f32 v33, v33
    v_exp_f32 v34, v34
    v_exp_f32 v35, v35
    v_exp_f32 v36, v36
    v_exp_f32 v37, v37
    s_waitcnt vmcnt(4)
    buffer_load_dwordx4 v[76:79], v1, s[32:35], s13 offen nt
    s_add_u32 s13, s13, s1
    v_exp_f32 v38, v38
    v_exp_f32 v39, v39
    v_exp_f32 v40, v40
    v_exp_f32 v41, v41
    v_exp_f32 v42, v42
    v_exp_f32 v43, v43
    v_exp_f32 v44, v44
    v_exp_f32 v45, v45
    v_exp_f32 v46, v46
    v_exp_f32 v47, v47
    v_add_f32 v21, v32, v33
    v_add_f32 v12, v34, v35
    v_add_f32 v21, v21, v36
    v_add_f32 v12, v12, v37
    v_add_f32 v21, v21, v38
    v_add_f32 v12, v12, v39
    s_waitcnt vmcnt(4)
    buffer_load_dwordx4 v[84:87], v3, s[40:43], s20 offen offset:768
    v_add_f32 v21, v21, v40
    v_add_f32 v12, v12, v41
    v_add_f32 v21, v21, v42
    v_add_f32 v12, v12, v43
    v_add_f32 v21, v21, v44
    v_add_f32 v12, v12, v45
    v_add_f32 v21, v21, v46
    v_add_f32 v12, v12, v47
    v_add_f32 v21, v21, v12
    v_and_b32 v12, 56, v0
    s_lshl_b32 s4, s3, 6
    v_add_u32 v12, s4, v12
    ds_write_b64 v12, v[20:21] offset:8704
    v_lshlrev_b32 v12, 3, v0
    s_waitcnt lgkmcnt(0)
    s_barrier
    s_waitcnt vmcnt(4)
    buffer_load_dwordx4 v[88:91], v1, s[32:35], s13 offen nt
    s_add_u32 s13, s13, s0
    ds_read_b64 v[24:25], v12 offset:8704
    s_waitcnt lgkmcnt(0)
    v_mov_b32 v12, v24
    s_nop 1
    v_max_f32_dpp v12, v12, v12 row_ror:8 row_mask:0xf bank_mask:0xf
    s_nop 1
    v_max_f32_dpp v12, v12, v12 row_ror:4 row_mask:0xf bank_mask:0xf
    s_nop 1
    v_max_f32_dpp v12, v12, v12 row_ror:2 row_mask:0xf bank_mask:0xf
    s_nop 1
    v_max_f32_dpp v12, v12, v12 row_ror:1 row_mask:0xf bank_mask:0xf
    s_nop 1
    v_max_f32_dpp v12, v12, v12 row_bcast:15 row_mask:0xa bank_mask:0xf
    s_nop 1
    v_max_f32_dpp v12, v12, v12 row_bcast:31 row_mask:0xc bank_mask:0xf
    s_nop 0
    v_readlane_b32 s4, v12, 63
    s_nop 1
    v_subrev_f32 v24, s4, v24
    v_subrev_f32 v20, s4, v20
    v_mul_f32 v24, 0x3fb8aa3b, v24
    v_mul_f32 v20, 0x3fb8aa3b, v20
    v_exp_f32 v24, v24
    v_exp_f32 v20, v20
    s_waitcnt vmcnt(4)
    buffer_load_dwordx4 v[96:99], v1, s[32:35], s13 offen nt
    s_add_u32 s13, s13, s1
    v_mul_f32 v25, v25, v24
    s_nop 1
    v_add_f32_dpp v25, v25, v25 row_ror:8 row_mask:0xf bank_mask:0xf
    s_nop 1
    v_add_f32_dpp v25, v25, v25 row_ror:4 row_mask:0xf bank_mask:0xf
    s_nop 1
    v_add_f32_dpp v25, v25, v25 row_ror:2 row_mask:0xf bank_mask:0xf
    s_nop 1
    v_add_f32_dpp v25, v25, v25 row_ror:1 row_mask:0xf bank_mask:0xf
    s_nop 1
    v_add_f32_dpp v25, v25, v25 row_bcast:15 row_mask:0xa bank_mask:0xf
    s_nop 1
    v_add_f32_dpp v25, v25, v25 row_bcast:31 row_mask:0xc bank_mask:0xf
    s_nop 0
    v_readlane_b32 s5, v25, 63
    s_nop 1
    v_rcp_f32 v21, s5
    s_nop 0
    v_mul_f32 v20, v20, v21
    v_mul_f32 v32, v32, v20
    v_mul_f32 v33, v33, v20
    v_mul_f32 v34, v34, v20
    v_mul_f32 v35, v35, v20
    v_mul_f32 v36, v36, v20
    v_mul_f32 v37, v37, v20
    s_waitcnt vmcnt(4)
    buffer_load_dwordx4 v[104:107], v3, s[40:43], s20 offen offset:1024
    s_add_u32 s20, s20, 10240
    v_mul_f32 v38, v38, v20
    v_mul_f32 v39, v39, v20
    v_mul_f32 v40, v40, v20
    v_mul_f32 v41, v41, v20
    v_mul_f32 v42, v42, v20
    v_mul_f32 v43, v43, v20
    v_mul_f32 v44, v44, v20
    v_mul_f32 v45, v45, v20
    v_mul_f32 v46, v46, v20
    v_mul_f32 v47, v47, v20
    v_cvt_pk_bf16_f32 v32, v32, v32
    v_cvt_pk_bf16_f32 v33, v33, v33
    v_cvt_pk_bf16_f32 v34, v34, v34
    v_cvt_pk_bf16_f32 v35, v35, v35
    v_cvt_pk_bf16_f32 v36, v36, v36
    v_cvt_pk_bf16_f32 v37, v37, v37
    s_waitcnt vmcnt(4)
    buffer_load_dwordx4 v[108:111], v1, s[32:35], s13 offen nt
    s_add_u32 s13, s13, s0
    v_cvt_pk_bf16_f32 v38, v38, v38
    v_cvt_pk_bf16_f32 v39, v39, v39
    v_cvt_pk_bf16_f32 v40, v40, v40
    v_cvt_pk_bf16_f32 v41, v41, v41
    v_cvt_pk_bf16_f32 v42, v42, v42
    v_cvt_pk_bf16_f32 v43, v43, v43
    v_cvt_pk_bf16_f32 v44, v44, v44
    v_cvt_pk_bf16_f32 v45, v45, v45
    v_cvt_pk_bf16_f32 v46, v46, v46
    v_cvt_pk_bf16_f32 v47, v47, v47
    v_and_b32 v8, 7, v0
    v_mul_u32_u24 v8, 80, v8
    v_lshl_add_u32 v8, v28, 4, v8
    s_mul_i32 s4, s3, 3328
    v_add_u32 v8, s4, v8
    s_mul_i32 s4, s3, 60
    s_waitcnt vmcnt(4)
    buffer_load_dwordx4 v[116:119], v1, s[32:35], s13 offen nt
    s_add_u32 s13, s13, s1
    s_add_u32 s4, s4, 0
    v_mul_u32_u24 v11, 15, v28
    v_add3_u32 v11, v11, v29, s4
    v_min_u32 v11, 639, v11
    v_lshrrev_b32 v9, 7, v11
    v_mul_u32_u24 v9, 640, v9
    v_and_b32 v26, 7, v11
    v_mul_u32_u24 v26, 80, v26
    v_add_u32 v9, v9, v26
    v_bfe_u32 v26, v11, 3, 4
    v_lshl_add_u32 v9, v26, 2, v9
    s_mul_i32 s4, s3, 60
    s_add_u32 s4, s4, 480
    v_mul_u32_u24 v11, 15, v28
    v_add3_u32 v11, v11, v29, s4
    s_mov_b32 s5, 640
    s_waitcnt vmcnt(4)
    buffer_load_dwordx4 v[140:143], v3, s[40:43], s20 offen offset:0
    v_cmp_gt_u32 s[22:23], s5, v11
    v_min_u32 v11, 639, v11
    v_lshrrev_b32 v10, 7, v11
    v_mul_u32_u24 v10, 640, v10
    v_and_b32 v26, 7, v11
    v_mul_u32_u24 v26, 80, v26
    v_add_u32 v10, v10, v26
    v_bfe_u32 v26, v11, 3, 4
    v_lshl_add_u32 v10, v26, 2, v10
    v_lshlrev_b32 v11, 2, v0
    s_and_b32 s4, s2, 7
    s_lshl_b32 s4, s4, 2
    s_lshr_b32 s4, 0x210cba98, s4
    s_and_b32 s4, s4, 15
    s_lshr_b32 s5, s2, 3
    s_mul_i32 s6, s4, 9
    s_add_u32 s6, s6, s5
    s_add_u32 s6, s6, 20
    s_cmp_lt_u32 s5, 9
    s_cselect_b32 s6, s6, 255
    s_sub_u32 s7, s4, 8
    s_mul_i32 s7, s7, 4
    s_add_u32 s7, s7, s5
    s_cmp_lt_u32 s5, 4
    s_cselect_b32 s7, s7, 255
    s_cmp_lt_u32 s4, 8
    s_cselect_b32 s101, s6, s7
    s_waitcnt vmcnt(4)
    buffer_load_dwordx4 v[144:147], v1, s[32:35], s13 offen nt
    s_add_u32 s13, s13, s0
    s_and_b32 s4, s2, 7
    s_lshl_b32 s4, s4, 2
    s_lshr_b32 s4, 0x210cba98, s4
    s_and_b32 s4, s4, 15
    s_lshr_b32 s5, s2, 3
    s_mul_i32 s6, s5, 69120
    s_mul_i32 s7, s4, 1152
    s_add_u32 s6, s6, s7
    s_mul_i32 s7, s5, 69120
    s_sub_u32 s5, s4, 8
    s_lshl_b32 s5, s5, 8
    s_add_u32 s7, s7, s5
    s_mul_i32 s5, s3, 23
    v_add_u32 v152, s5, v0
    v_mul_u32_u24 v153, 7282, v152
    v_lshrrev_b32 v153, 16, v153
    v_mul_u32_u24 v153, 2304, v153
    v_lshl_add_u32 v153, v152, 7, v153
    s_mul_i32 s5, s3, 14
    v_add_u32 v152, s5, v0
    v_lshrrev_b32 v154, 1, v152
    v_mul_u32_u24 v154, 1024, v154
    v_lshl_add_u32 v154, v152, 7, v154
    s_cmp_lt_u32 s4, 8
    s_cselect_b32 s14, s6, s7
    s_mov_b32 s15, 16383
    s_cselect_b32 s15, 8388607, s15
    s_cselect_b32 s36, s16, s18
    s_cselect_b32 s37, s17, s19
    s_cselect_b64 vcc, -1, 0
    s_and_b32 s37, s37, 0xffff
    s_mov_b32 s38, 2211840
    s_mov_b32 s39, 0x20000
    v_cndmask_b32 v152, v154, v153, vcc
    s_waitcnt vmcnt(4)
    buffer_load_dwordx4 v[160:163], v1, s[32:35], s13 offen nt
    s_add_u32 s13, s13, s1
    v_and_b32 v12, v32, v4
    v_and_b32 v13, v32, v5
    v_and_b32 v14, v32, v6
    v_and_b32 v15, v32, v7
    s_nop 1
    v_mfma_f32_16x16x32_bf16 v[20:23], v[100:103], v[12:15], 0
    v_mfma_f32_16x16x32_bf16 v[24:27], v[112:115], v[12:15], 0
    v_and_b32 v16, v33, v4
    v_and_b32 v17, v33, v5
    v_and_b32 v18, v33, v6
    v_and_b32 v19, v33, v7
    s_nop 1
    v_mfma_f32_16x16x32_bf16 v[20:23], v[148:151], v[16:19], v[20:23]
    v_mfma_f32_16x16x32_bf16 v[24:27], v[156:159], v[16:19], v[24:27]
    v_and_b32 v12, v34, v4
    v_and_b32 v13, v34, v5
    v_and_b32 v14, v34, v6
    v_and_b32 v15, v34, v7
    s_waitcnt vmcnt(4)
    buffer_load_dwordx4 v[164:167], v3, s[40:43], s20 offen offset:256
    v_mfma_f32_16x16x32_bf16 v[20:23], v[176:179], v[12:15], v[20:23]
    v_mfma_f32_16x16x32_bf16 v[24:27], v[184:187], v[12:15], v[24:27]
    v_and_b32 v16, v35, v4
    v_and_b32 v17, v35, v5
    v_and_b32 v18, v35, v6
    v_and_b32 v19, v35, v7
    s_nop 1
    v_mfma_f32_16x16x32_bf16 v[20:23], v[128:131], v[16:19], v[20:23]
    v_mfma_f32_16x16x32_bf16 v[24:27], v[132:135], v[16:19], v[24:27]
    v_and_b32 v12, v36, v4
    v_and_b32 v13, v36, v5
    v_and_b32 v14, v36, v6
    v_and_b32 v15, v36, v7
    s_nop 1
    v_mfma_f32_16x16x32_bf16 v[20:23], v[196:199], v[12:15], v[20:23]
    v_mfma_f32_16x16x32_bf16 v[24:27], v[204:207], v[12:15], v[24:27]
    v_and_b32 v16, v37, v4
    v_and_b32 v17, v37, v5
    s_waitcnt vmcnt(4)
    buffer_load_dwordx4 v[172:175], v1, s[32:35], s13 offen nt
    s_add_u32 s13, s13, s0
    v_and_b32 v18, v37, v6
    v_and_b32 v19, v37, v7
    s_nop 1
    v_mfma_f32_16x16x32_bf16 v[20:23], v[224:227], v[16:19], v[20:23]
    v_mfma_f32_16x16x32_bf16 v[24:27], v[236:239], v[16:19], v[24:27]
    v_and_b32 v12, v38, v4
    v_and_b32 v13, v38, v5
    v_and_b32 v14, v38, v6
    v_and_b32 v15, v38, v7
    s_nop 1
    v_mfma_f32_16x16x32_bf16 v[20:23], v[64:67], v[12:15], v[20:23]
    v_mfma_f32_16x16x32_bf16 v[24:27], v[80:83], v[12:15], v[24:27]
    v_and_b32 v16, v39, v4
    v_and_b32 v17, v39, v5
    v_and_b32 v18, v39, v6
    v_and_b32 v19, v39, v7
    s_nop 1
    v_mfma_f32_16x16x32_bf16 v[20:23], v[52:55], v[16:19], v[20:23]
    v_mfma_f32_16x16x32_bf16 v[24:27], v[56:59], v[16:19], v[24:27]
    s_waitcnt vmcnt(4)
    buffer_load_dwordx4 v[180:183], v1, s[32:35], s13 offen nt
    s_add_u32 s13, s13, s1
    v_and_b32 v12, v40, v4
    v_and_b32 v13, v40, v5
    v_and_b32 v14, v40, v6
    v_and_b32 v15, v40, v7
    s_nop 1
    v_mfma_f32_16x16x32_bf16 v[20:23], v[68:71], v[12:15], v[20:23]
    v_mfma_f32_16x16x32_bf16 v[24:27], v[76:79], v[12:15], v[24:27]
    v_and_b32 v16, v41, v4
    v_and_b32 v17, v41, v5
    v_and_b32 v18, v41, v6
    v_and_b32 v19, v41, v7
    s_nop 1
    v_mfma_f32_16x16x32_bf16 v[20:23], v[88:91], v[16:19], v[20:23]
    v_mfma_f32_16x16x32_bf16 v[24:27], v[96:99], v[16:19], v[24:27]
    v_cmp_eq_u32 vcc, 0, v2
    s_nop 5
    s_cbranch_vccz L_flagok
L_flag:
    s_sleep 2
    v_and_b32 v2, 7, v0
    v_lshlrev_b32 v2, 2, v2
    buffer_load_dword v2, v2, s[52:55], 0 offen sc1
    s_waitcnt vmcnt(0)
    v_cmp_eq_u32 vcc, 0, v2
    s_nop 3
    s_cbranch_vccz L_flagok
    s_sub_u32 s9, s9, 1
    s_cmp_lt_i32 s9, 0
    s_cbranch_scc1 L_flagok
    s_branch L_flag
L_flagok:
    s_waitcnt vmcnt(4)
    buffer_load_dwordx4 v[188:191], v3, s[40:43], s20 offen offset:512
    s_mov_b32 s56, s16
    s_and_b32 s57, s17, 0xffff
    s_mov_b32 s58, 2211840
    s_mov_b32 s59, 0x20000
    v_lshrrev_b32 v2, 3, v0
    v_mul_u32_u24 v2, 3456, v2
    v_and_b32 v192, 1, v28
    v_lshlrev_b32 v192, 2, v192
    s_and_b32 s4, s3, 1
    s_lshl_b32 s5, s4, 1
    v_xor_b32 v192, s5, v192
    v_xor_b32 v192, v0, v192
    v_and_b32 v192, 7, v192
    v_lshl_add_u32 v2, v192, 4, v2
    s_lshr_b32 s5, s3, 1
    s_mul_i32 s5, s5, 15
    s_waitcnt vmcnt(4)
    buffer_load_dwordx4 v[200:203], v1, s[32:35], s13 offen nt
    s_add_u32 s13, s13, s0
    s_lshl_b32 s4, s4, 3
    s_add_u32 s5, s5, s4
    s_mul_i32 s5, s5, 3456
    s_mov_b32 s21, s5
    s_lshl_b32 s24, s3, 10
    s_add_u32 s24, s24, 35840
    v_and_b32 v12, v42, v4
    v_and_b32 v13, v42, v5
    v_and_b32 v14, v42, v6
    v_and_b32 v15, v42, v7
    s_nop 1
    v_mfma_f32_16x16x32_bf16 v[20:23], v[108:111], v[12:15], v[20:23]
    v_mfma_f32_16x16x32_bf16 v[24:27], v[116:119], v[12:15], v[24:27]
    v_and_b32 v16, v43, v4
    v_and_b32 v17, v43, v5
    v_and_b32 v18, v43, v6
    v_and_b32 v19, v43, v7
    s_waitcnt vmcnt(4)
    buffer_load_dwordx4 v[208:211], v1, s[32:35], s13 offen nt
    s_add_u32 s13, s13, s1
    v_mfma_f32_16x16x32_bf16 v[20:23], v[144:147], v[16:19], v[20:23]
    v_mfma_f32_16x16x32_bf16 v[24:27], v[160:163], v[16:19], v[24:27]
    s_waitcnt vmcnt(4)
    buffer_load_dwordx4 v[212:215], v3, s[40:43], s20 offen offset:768
    s_waitcnt vmcnt(4)
    buffer_load_dwordx4 v[220:223], v1, s[32:35], s13 offen nt
    s_add_u32 s13, s13, s0
    v_and_b32 v12, v44, v4
    v_and_b32 v13, v44, v5
    v_and_b32 v14, v44, v6
    v_and_b32 v15, v44, v7
    s_nop 1
    v_mfma_f32_16x16x32_bf16 v[20:23], v[172:175], v[12:15], v[20:23]
    v_mfma_f32_16x16x32_bf16 v[24:27], v[180:183], v[12:15], v[24:27]
    s_waitcnt vmcnt(4)
    buffer_load_dwordx4 v[228:231], v1, s[32:35], s13 offen nt
    s_add_u32 s13, s13, s1
    s_waitcnt vmcnt(4)
    buffer_load_dwordx4 v[232:235], v3, s[40:43], s20 offen offset:1024
    s_add_u32 s20, s20, 10240
    s_waitcnt vmcnt(4)
    buffer_load_dwordx4 v[240:243], v1, s[32:35], s13 offen nt
    s_add_u32 s13, s13, s0
    v_and_b32 v16, v45, v4
    v_and_b32 v17, v45, v5
    v_and_b32 v18, v45, v6
    v_and_b32 v19, v45, v7
    s_nop 1
    v_mfma_f32_16x16x32_bf16 v[20:23], v[200:203], v[16:19], v[20:23]
    v_mfma_f32_16x16x32_bf16 v[24:27], v[208:211], v[16:19], v[24:27]
    s_waitcnt vmcnt(4)
    buffer_load_dwordx4 v[248:251], v1, s[32:35], s13 offen nt
    s_waitcnt vmcnt(4)
    buffer_load_dwordx4 v[252:255], v3, s[40:43], s20 offen offset:0
    s_waitcnt vmcnt(4)
    buffer_load_dwordx4 v[72:75], v3, s[40:43], s20 offen offset:256
    v_and_b32 v12, v46, v4
    v_and_b32 v13, v46, v5
    v_and_b32 v14, v46, v6
    v_and_b32 v15, v46, v7
    s_nop 1
    v_mfma_f32_16x16x32_bf16 v[20:23], v[220:223], v[12:15], v[20:23]
    v_mfma_f32_16x16x32_bf16 v[24:27], v[228:231], v[12:15], v[24:27]
    s_waitcnt vmcnt(4)
    buffer_load_dwordx4 v[92:95], v3, s[40:43], s20 offen offset:512
    s_waitcnt vmcnt(4)
    buffer_load_dwordx4 v[100:103], v3, s[40:43], s20 offen offset:768
    s_waitcnt vmcnt(4)
    buffer_load_dwordx4 v[112:115], v3, s[40:43], s20 offen offset:1024
    v_and_b32 v16, v47, v4
    v_and_b32 v17, v47, v5
    v_and_b32 v18, v47, v6
    v_and_b32 v19, v47, v7
    s_nop 1
    v_mfma_f32_16x16x32_bf16 v[20:23], v[240:243], v[16:19], v[20:23]
    v_mfma_f32_16x16x32_bf16 v[24:27], v[248:251], v[16:19], v[24:27]
    s_nop 7
    v_cndmask_b32 v20, v24, v20, s[10:11]
    v_cndmask_b32 v21, v25, v21, s[10:11]
    v_cndmask_b32 v22, v26, v22, s[10:11]
    v_cndmask_b32 v23, v27, v23, s[10:11]
    ds_write_b128 v30, v[20:23] offset:0
    s_waitcnt lgkmcnt(0)
    s_barrier
    ds_read_b128 v[32:35], v31 offset:0
    s_mov_b32 exec_lo, s15
    s_mov_b32 exec_hi, 0
    buffer_load_dword v155, v152, s[36:39], s14 offen
    s_mov_b64 exec, -1
    s_waitcnt lgkmcnt(0)
    v_add_f32_dpp v32, v32, v32 row_ror:8 row_mask:0xf bank_mask:0xf
    v_add_f32_dpp v33, v33, v33 row_ror:8 row_mask:0xf bank_mask:0xf
    v_add_f32_dpp v34, v34, v34 row_ror:8 row_mask:0xf bank_mask:0xf
    v_add_f32_dpp v35, v35, v35 row_ror:8 row_mask:0xf bank_mask:0xf
    v_add_f32_dpp v32, v32, v32 row_ror:4 row_mask:0xf bank_mask:0xf
    v_add_f32_dpp v33, v33, v33 row_ror:4 row_mask:0xf bank_mask:0xf
    v_add_f32_dpp v34, v34, v34 row_ror:4 row_mask:0xf bank_mask:0xf
    v_add_f32_dpp v35, v35, v35 row_ror:4 row_mask:0xf bank_mask:0xf
    v_add_f32_dpp v32, v32, v32 row_ror:2 row_mask:0xf bank_mask:0xf
    v_add_f32_dpp v33, v33, v33 row_ror:2 row_mask:0xf bank_mask:0xf
    v_add_f32_dpp v34, v34, v34 row_ror:2 row_mask:0xf bank_mask:0xf
    v_add_f32_dpp v35, v35, v35 row_ror:2 row_mask:0xf bank_mask:0xf
    v_add_f32_dpp v32, v32, v32 row_ror:1 row_mask:0xf bank_mask:0xf
    v_add_f32_dpp v33, v33, v33 row_ror:1 row_mask:0xf bank_mask:0xf
    v_add_f32_dpp v34, v34, v34 row_ror:1 row_mask:0xf bank_mask:0xf
    v_add_f32_dpp v35, v35, v35 row_ror:1 row_mask:0xf bank_mask:0xf
    v_cvt_pk_bf16_f32 v32, v32, v32
    v_cvt_pk_bf16_f32 v33, v33, v33
    v_cvt_pk_bf16_f32 v34, v34, v34
    v_cvt_pk_bf16_f32 v35, v35, v35
    v_and_b32 v12, v32, v4
    v_and_b32 v13, v32, v5
    v_and_b32 v14, v32, v6
    v_and_b32 v15, v32, v7
    s_nop 1
    v_mfma_f32_16x16x32_bf16 v[148:151], v[120:123], v[12:15], 0
    v_and_b32 v16, v33, v4
    v_mfma_f32_16x16x32_bf16 v[156:159], v[168:171], v[12:15], 0
    v_and_b32 v17, v33, v5
    v_mfma_f32_16x16x32_bf16 v[176:179], v[124:127], v[12:15], 0
    v_and_b32 v18, v33, v6
    v_mfma_f32_16x16x32_bf16 v[184:187], v[136:139], v[12:15], 0
    v_and_b32 v19, v33, v7
    v_mfma_f32_16x16x32_bf16 v[128:131], v[216:219], v[12:15], 0
    s_nop 0
    v_mfma_f32_16x16x32_bf16 v[148:151], v[244:247], v[16:19], v[148:151]
    v_and_b32 v20, v34, v4
    v_mfma_f32_16x16x32_bf16 v[156:159], v[48:51], v[16:19], v[156:159]
    v_and_b32 v21, v34, v5
    v_mfma_f32_16x16x32_bf16 v[176:179], v[60:63], v[16:19], v[176:179]
    v_and_b32 v22, v34, v6
    v_mfma_f32_16x16x32_bf16 v[184:187], v[84:87], v[16:19], v[184:187]
    v_and_b32 v23, v34, v7
    v_mfma_f32_16x16x32_bf16 v[128:131], v[104:107], v[16:19], v[128:131]
    s_nop 0
    v_mfma_f32_16x16x32_bf16 v[148:151], v[140:143], v[20:23], v[148:151]
    v_and_b32 v24, v35, v4
    v_mfma_f32_16x16x32_bf16 v[156:159], v[164:167], v[20:23], v[156:159]
    v_and_b32 v25, v35, v5
    v_mfma_f32_16x16x32_bf16 v[176:179], v[188:191], v[20:23], v[176:179]
    v_and_b32 v26, v35, v6
    v_mfma_f32_16x16x32_bf16 v[184:187], v[212:215], v[20:23], v[184:187]
    v_and_b32 v27, v35, v7
    v_mfma_f32_16x16x32_bf16 v[128:131], v[232:235], v[20:23], v[128:131]
    s_waitcnt vmcnt(5)
    v_mfma_f32_16x16x32_bf16 v[148:151], v[252:255], v[24:27], v[148:151]
    s_waitcnt vmcnt(4)
    v_mfma_f32_16x16x32_bf16 v[156:159], v[72:75], v[24:27], v[156:159]
    s_waitcnt vmcnt(3)
    v_mfma_f32_16x16x32_bf16 v[176:179], v[92:95], v[24:27], v[176:179]
    s_waitcnt vmcnt(2)
    v_mfma_f32_16x16x32_bf16 v[184:187], v[100:103], v[24:27], v[184:187]
    s_waitcnt vmcnt(1)
    v_mfma_f32_16x16x32_bf16 v[128:131], v[112:115], v[24:27], v[128:131]
    s_mov_b64 exec, s[10:11]
    ds_write_b128 v8, v[148:151] offset:9216
    ds_write_b128 v8, v[156:159] offset:9856
    s_nop 0
    ds_write_b128 v8, v[176:179] offset:10496
    s_nop 0
    ds_write_b128 v8, v[184:187] offset:11136
    s_nop 0
    ds_write_b128 v8, v[128:131] offset:11776
    s_mov_b64 exec, -1
    s_mul_i32 s4, s27, 3072
    s_lshl_b32 s5, s3, 8
    s_add_u32 s4, s4, s5
    s_mov_b32 s6, 0x80008000
    s_mov_b32 s7, 0x80008000
    s_waitcnt lgkmcnt(0)
    s_barrier
    ds_read2st64_b32 v[32:33], v9 offset0:36 offset1:49
    ds_read2st64_b32 v[34:35], v9 offset0:62 offset1:75
    ds_read2st64_b32 v[36:37], v9 offset0:88 offset1:101
    ds_read2st64_b32 v[38:39], v9 offset0:114 offset1:127
    ds_read2st64_b32 v[40:41], v10 offset0:36 offset1:49
    ds_read2st64_b32 v[42:43], v10 offset0:62 offset1:75
    ds_read2st64_b32 v[44:45], v10 offset0:88 offset1:101
    ds_read2st64_b32 v[46:47], v10 offset0:114 offset1:127
    s_waitcnt lgkmcnt(4)
    v_add_f32 v32, v32, v36
    v_add_f32 v33, v33, v37
    v_add_f32 v34, v34, v38
    v_add_f32 v35, v35, v39
    v_add_f32 v32, v32, v34
    v_add_f32 v33, v33, v35
    v_add_f32 v32, v32, v33
    v_cndmask_b32 v32, v32, 1.0, s[6:7]
    buffer_atomic_add_f32 v32, v11, s[48:51], s4 offen offset:0
    s_waitcnt lgkmcnt(0)
    v_add_f32 v40, v40, v44
    v_add_f32 v41, v41, v45
    v_add_f32 v42, v42, v46
    v_add_f32 v43, v43, v47
    v_add_f32 v40, v40, v42
    v_add_f32 v41, v41, v43
    v_add_f32 v40, v40, v41
    v_cndmask_b32 v40, 0, v40, s[22:23]
    v_cndmask_b32 v40, v40, 1.0, s[6:7]
    s_cmp_ge_u32 s3, 3
    s_nop 0
    s_cbranch_scc1 L_arr
    buffer_atomic_add_f32 v40, v11, s[48:51], s4 offen offset:2048
L_arr:
    s_cmp_ge_u32 s101, 47
    s_cbranch_scc1 L_fin
    s_mov_b32 s58, 2211840
    s_mov_b32 s59, 0x20000
    s_cmp_lt_u32 s101, 20
    s_cbranch_scc1 L_ffn2
    s_mov_b32 s100, 1
    s_sub_u32 s101, s101, 20
    s_mov_b32 s56, s16
    s_and_b32 s57, s17, 0xffff
    s_lshl_b32 s4, s101, 7
    s_add_u32 s21, s21, s4
    v_lshrrev_b32 v13, 2, v0
    v_mul_u32_u24 v13, 30, v13
    v_and_b32 v14, 3, v0
    v_lshl_add_u32 v13, v14, 3, v13
    s_mul_i32 s4, s3, 1280
    buffer_load_dwordx2 v[220:221], v13, s[44:47], s4 offen offset:0
    buffer_load_dwordx2 v[222:223], v13, s[44:47], s4 offen offset:480
    buffer_load_dwordx2 v[224:225], v13, s[44:47], s4 offen offset:960
    s_mov_b32 m0, s24
    s_nop 0
    buffer_load_dwordx4 v2, s[56:59], s21 offen lds
    s_add_u32 s21, s21, 207360
    s_add_u32 s24, s24, 8192
    s_mov_b32 m0, s24
    s_nop 0
    buffer_load_dwordx4 v2, s[56:59], s21 offen lds
    s_add_u32 s21, s21, 207360
    s_add_u32 s24, s24, 8192
    s_mov_b32 m0, s24
    s_nop 0
    buffer_load_dwordx4 v2, s[56:59], s21 offen lds
    s_add_u32 s21, s21, 207360
    s_add_u32 s24, s24, 8192
    s_mov_b32 m0, s24
    s_nop 0
    buffer_load_dwordx4 v2, s[56:59], s21 offen lds
    s_add_u32 s21, s21, 207360
    s_add_u32 s24, s24, 8192
    s_mov_b32 m0, s24
    s_nop 0
    buffer_load_dwordx4 v2, s[56:59], s21 offen lds
    s_add_u32 s21, s21, 207360
    s_add_u32 s24, s24, 8192
    s_mov_b32 m0, s24
    s_nop 0
    buffer_load_dwordx4 v2, s[56:59], s21 offen lds
    s_add_u32 s21, s21, 207360
    s_add_u32 s24, s24, 8192
    s_mov_b32 m0, s24
    s_nop 0
    buffer_load_dwordx4 v2, s[56:59], s21 offen lds
    s_add_u32 s21, s21, 207360
    s_add_u32 s24, s24, 8192
    s_mov_b32 m0, s24
    s_nop 0
    buffer_load_dwordx4 v2, s[56:59], s21 offen lds
    s_add_u32 s21, s21, 207360
    s_add_u32 s24, s24, 8192
    s_mov_b32 m0, s24
    s_nop 0
    buffer_load_dwordx4 v2, s[56:59], s21 offen lds
    s_add_u32 s21, s21, 207360
    s_add_u32 s24, s24, 8192
    s_mov_b32 m0, s24
    s_nop 0
    buffer_load_dwordx4 v2, s[56:59], s21 offen lds
    s_add_u32 s21, s21, 207360
    s_add_u32 s24, s24, 8192
    s_mov_b32 m0, s24
    s_nop 0
    buffer_load_dwordx4 v2, s[56:59], s21 offen lds
    v_mov_b32 v208, 0
    v_mov_b32 v209, 0
    v_mov_b32 v210, 0
    v_mov_b32 v211, 0
    v_mov_b32 v212, 0
    v_mov_b32 v213, 0
    v_mov_b32 v214, 0
    v_mov_b32 v215, 0
    v_mov_b32 v216, 0
    v_mov_b32 v217, 0
    v_mov_b32 v218, 0
    v_mov_b32 v219, 0
    v_mov_b32 v192, 0
    v_mov_b32 v193, 0
    v_mov_b32 v194, 0
    v_mov_b32 v195, 0x42000000
    v_lshlrev_b32 v18, 3, v0
    s_mul_i32 s5, s3, 1408
    v_add_u32 v18, s5, v18
    v_lshlrev_b32 v8, 10, v28
    v_lshrrev_b32 v12, 2, v29
    v_lshl_add_u32 v8, v12, 7, v8
    v_and_b32 v12, 2, v12
    v_and_b32 v13, 1, v28
    v_or_b32 v12, v12, v13
    s_and_b32 s4, s3, 3
    v_xor_b32 v12, s4, v12
    v_lshl_add_u32 v8, v12, 5, v8
    v_and_b32 v12, 3, v29
    v_lshl_add_u32 v8, v12, 3, v8
    v_add_u32 v8, 35840, v8
    v_add_u32 v9, 45056, v8
    v_and_b32 v19, 7, v0
    v_mul_u32_u24 v19, 1408, v19
    v_lshl_add_u32 v19, v28, 4, v19
    v_lshrrev_b32 v12, 3, v29
    v_lshl_add_u32 v19, v12, 6, v19
    v_lshlrev_b32 v16, 5, v29
    v_lshl_add_u32 v16, v28, 3, v16
    s_lshl_b32 s7, s101, 2
    s_add_u32 s7, s7, s3
    s_lshl_b32 s7, s7, 8
    s_mul_i32 s6, s3, 3072
    s_mov_b32 s12, 0x77777777
    s_mov_b32 s13, 0x77777777
    s_mov_b32 s14, 0x88888888
    s_mov_b32 s15, 0x88888888
    s_waitcnt vmcnt(0)
    v_lshlrev_b32 v196, 16, v220
    v_and_b32 v197, 0xffff0000, v220
    v_lshlrev_b32 v198, 16, v221
    v_and_b32 v199, 0xffff0000, v221
    v_lshlrev_b32 v200, 16, v222
    v_and_b32 v201, 0xffff0000, v222
    v_lshlrev_b32 v202, 16, v223
    v_and_b32 v203, 0xffff0000, v223
    v_lshlrev_b32 v204, 16, v224
    v_and_b32 v205, 0xffff0000, v224
    v_lshlrev_b32 v206, 16, v225
    v_and_b32 v207, 0xffff0000, v225
    s_mov_b32 s20, 0x00003f80
    s_mov_b32 s21, 0x3f800000
    s_mov_b32 s24, 0x3f803f80
    v_mov_b32 v214, 0xbacccccd
    v_mov_b32 v215, -1
    v_mov_b32 v216, -1
    v_mov_b32 v217, -1
    s_mov_b32 exec_lo, 0
    s_mov_b32 exec_hi, 0xfffff800
    v_mov_b32 v204, 0
    v_mov_b32 v205, 0
    v_mov_b32 v216, 0
    s_mov_b32 exec_hi, 0xfffffc00
    v_mov_b32 v206, 0
    v_mov_b32 v207, 0
    v_mov_b32 v217, 0
    s_mov_b64 exec, s[14:15]
    v_mov_b32 v199, 0xc2000000
    v_mov_b32 v203, 0xc2000000
    v_mov_b32 v207, 0xc2000000
    v_mov_b32 v215, 0xffff
    v_and_b32 v217, 0xffff, v217
    s_mov_b32 exec_lo, 0
    s_mov_b32 exec_hi, 0xffff0000
    v_mov_b32 v207, 0xc2000000
    s_mov_b64 exec, -1
    s_barrier
    s_mul_i32 s8, s101, 104
    s_and_b32 s8, s8, 0xffffffc0
    s_add_u32 s8, s8, s6
    buffer_load_dword v24, off, s[48:51], s8 offset:60 sc1
    s_cmp_ge_u32 s3, 4
    s_cbranch_scc1 L_f1_notr
    ds_read_b64_tr_b16 v[48:49], v8 offset:0
    ds_read_b64_tr_b16 v[50:51], v8 offset:512
    ds_read_b64_tr_b16 v[52:53], v8 offset:4096
    ds_read_b64_tr_b16 v[54:55], v8 offset:4608
    ds_read_b64_tr_b16 v[56:57], v8 offset:8192
    ds_read_b64_tr_b16 v[58:59], v8 offset:8704
    ds_read_b64_tr_b16 v[60:61], v8 offset:12288
    ds_read_b64_tr_b16 v[62:63], v8 offset:12800
    ds_read_b64_tr_b16 v[64:65], v8 offset:16384
    ds_read_b64_tr_b16 v[66:67], v8 offset:16896
    ds_read_b64_tr_b16 v[68:69], v8 offset:20480
    ds_read_b64_tr_b16 v[70:71], v8 offset:20992
    ds_read_b64_tr_b16 v[72:73], v8 offset:24576
    ds_read_b64_tr_b16 v[74:75], v8 offset:25088
    ds_read_b64_tr_b16 v[76:77], v8 offset:28672
    ds_read_b64_tr_b16 v[78:79], v8 offset:29184
    ds_read_b64_tr_b16 v[80:81], v8 offset:32768
    ds_read_b64_tr_b16 v[82:83], v8 offset:33280
    ds_read_b64_tr_b16 v[84:85], v8 offset:36864
    ds_read_b64_tr_b16 v[86:87], v8 offset:37376
    ds_read_b64_tr_b16 v[88:89], v8 offset:40960
    ds_read_b64_tr_b16 v[90:91], v8 offset:41472
    ds_read_b64_tr_b16 v[92:93], v9 offset:0
    ds_read_b64_tr_b16 v[94:95], v9 offset:512
    ds_read_b64_tr_b16 v[96:97], v9 offset:4096
    ds_read_b64_tr_b16 v[98:99], v9 offset:4608
    ds_read_b64_tr_b16 v[100:101], v9 offset:8192
    ds_read_b64_tr_b16 v[102:103], v9 offset:8704
    ds_read_b64_tr_b16 v[104:105], v9 offset:12288
    ds_read_b64_tr_b16 v[106:107], v9 offset:12800
    ds_read_b64_tr_b16 v[108:109], v9 offset:16384
    ds_read_b64_tr_b16 v[110:111], v9 offset:16896
    ds_read_b64_tr_b16 v[112:113], v9 offset:20480
    ds_read_b64_tr_b16 v[114:115], v9 offset:20992
    ds_read_b64_tr_b16 v[116:117], v9 offset:24576
    ds_read_b64_tr_b16 v[118:119], v9 offset:25088
    ds_read_b64_tr_b16 v[120:121], v9 offset:28672
    ds_read_b64_tr_b16 v[122:123], v9 offset:29184
    ds_read_b64_tr_b16 v[124:125], v9 offset:32768
    ds_read_b64_tr_b16 v[126:127], v9 offset:33280
    ds_read_b64_tr_b16 v[128:129], v9 offset:36864
    ds_read_b64_tr_b16 v[130:131], v9 offset:37376
    ds_read_b64_tr_b16 v[132:133], v9 offset:40960
    ds_read_b64_tr_b16 v[134:135], v9 offset:41472
L_f1_notr:
    s_branch L_f1_gate
L_f1_poll:
    s_waitcnt vmcnt(0)
    v_min3_f32 v20, v187, v191, v195
    v_cmp_gt_f32 vcc, 0x42000000, v20
    s_and_b64 vcc, vcc, s[14:15]
    s_nop 2
    s_cbranch_scc0 L_f1_go
    s_sub_u32 s9, s9, 1
    s_cmp_lt_i32 s9, 0
    s_cbranch_scc1 L_f1_go
    v_readlane_b32 s4, v187, 3
    s_cmp_ge_u32 s4, 0x41f80000
    s_nop 2
    s_cbranch_scc1 L_f1_full
L_f1_regate:
    s_sleep 1
    buffer_load_dword v24, off, s[48:51], s8 offset:60 sc1
L_f1_gate:
    s_waitcnt vmcnt(0)
    v_readfirstlane_b32 s4, v24
    s_cmp_ge_u32 s4, 0x41f80000
    s_nop 2
    s_cbranch_scc1 L_f1_full
    s_sub_u32 s9, s9, 1
    s_cmp_lt_i32 s9, 0
    s_cbranch_scc1 L_f1_full
    s_branch L_f1_regate
L_f1_full:
    buffer_load_dwordx4 v[184:187], v1, s[48:51], s6 offen sc1
    buffer_load_dwordx4 v[188:191], v1, s[48:51], s6 offen offset:1024 sc1
    s_mov_b32 exec_hi, 0xffff
    buffer_load_dwordx4 v[192:195], v1, s[48:51], s6 offen offset:2048 sc1
    s_mov_b32 exec_hi, -1
    s_branch L_f1_poll
L_f1_go:
    v_cvt_pk_bf16_f32 v208, v184, v185
    v_cvt_pk_bf16_f32 v209, v186, v187
    v_cvt_pk_bf16_f32 v210, v188, v189
    v_cvt_pk_bf16_f32 v211, v190, v191
    v_cvt_pk_bf16_f32 v212, v192, v193
    v_cvt_pk_bf16_f32 v213, v194, v195
    v_dot2_f32_bf16 v184, v208, s20, v196
    v_dot2_f32_bf16 v185, v208, s21, v197
    v_dot2_f32_bf16 v186, v209, s20, v198
    v_dot2_f32_bf16 v187, v209, s21, v199
    v_dot2_f32_bf16 v188, v210, s20, v200
    v_dot2_f32_bf16 v189, v210, s21, v201
    v_dot2_f32_bf16 v190, v211, s20, v202
    v_dot2_f32_bf16 v191, v211, s21, v203
    v_dot2_f32_bf16 v192, v212, s20, v204
    v_dot2_f32_bf16 v193, v212, s21, v205
    v_dot2_f32_bf16 v194, v213, s20, v206
    v_dot2_f32_bf16 v195, v213, s21, v207
    v_cvt_pk_bf16_f32 v208, v184, v185
    v_cvt_pk_bf16_f32 v209, v186, v187
    v_cvt_pk_bf16_f32 v210, v188, v189
    v_cvt_pk_bf16_f32 v211, v190, v191
    v_cvt_pk_bf16_f32 v212, v192, v193
    v_cvt_pk_bf16_f32 v213, v194, v195
    v_dot2_f32_bf16 v20, v208, s24, 0
    v_dot2_f32_bf16 v21, v209, s24, 0
    v_dot2_f32_bf16 v20, v210, s24, v20
    v_dot2_f32_bf16 v21, v211, s24, v21
    v_dot2_f32_bf16 v20, v212, s24, v20
    v_dot2_f32_bf16 v21, v213, s24, v21
    v_lshlrev_b32 v196, 16, v208
    v_and_b32 v197, 0xffff0000, v208
    s_nop 0
    v_add_f32 v20, v20, v21
    v_lshlrev_b32 v198, 16, v209
    v_and_b32 v199, 0xffff0000, v209
    v_add_f32_dpp v20, v20, v20 row_ror:8 row_mask:0xf bank_mask:0xf
    v_lshlrev_b32 v200, 16, v210
    v_and_b32 v201, 0xffff0000, v210
    v_add_f32_dpp v20, v20, v20 row_ror:4 row_mask:0xf bank_mask:0xf
    v_lshlrev_b32 v202, 16, v211
    v_and_b32 v203, 0xffff0000, v211
    v_add_f32_dpp v20, v20, v20 row_ror:2 row_mask:0xf bank_mask:0xf
    v_lshlrev_b32 v204, 16, v212
    v_and_b32 v205, 0xffff0000, v212
    v_add_f32_dpp v20, v20, v20 row_ror:1 row_mask:0xf bank_mask:0xf
    v_lshlrev_b32 v206, 16, v213
    v_and_b32 v207, 0xffff0000, v213
    v_add_f32_dpp v20, v20, v20 row_bcast:15 row_mask:0xa bank_mask:0xf
    s_nop 1
    v_add_f32_dpp v20, v20, v20 row_bcast:31 row_mask:0xc bank_mask:0xf
    s_nop 0
    v_readlane_b32 s4, v20, 63
    s_nop 1
    v_mul_f32 v24, s4, v214
    v_add_f32 v184, v196, v24
    v_add_f32 v185, v197, v24
    v_add_f32 v186, v198, v24
    v_add_f32 v187, v199, v24
    v_add_f32 v188, v200, v24
    v_add_f32 v189, v201, v24
    v_add_f32 v190, v202, v24
    v_add_f32 v191, v203, v24
    v_add_f32 v192, v204, v24
    v_add_f32 v193, v205, v24
    v_add_f32 v194, v206, v24
    v_add_f32 v195, v207, v24
    v_mul_f32 v20, v184, v184
    v_mul_f32 v21, v185, v185
    v_fmac_f32 v20, v186, v186
    v_fmac_f32 v20, v188, v188
    v_fmac_f32 v21, v189, v189
    v_fmac_f32 v20, v190, v190
    s_mov_b32 exec_hi, 0x7ff
    v_fmac_f32 v20, v192, v192
    v_fmac_f32 v21, v193, v193
    s_mov_b32 exec_hi, 0x3ff
    v_fmac_f32 v20, v194, v194
    s_and_b64 exec, exec, s[12:13]
    v_fmac_f32 v21, v195, v195
    s_mov_b64 exec, s[12:13]
    v_fmac_f32 v21, v187, v187
    v_fmac_f32 v21, v191, v191
    s_mov_b64 exec, -1
    v_add_f32 v20, v20, v21
    v_cvt_pk_bf16_f32 v24, v24, v24
    v_and_b32 v24, 0xffff0000, v24
    v_add_f32_dpp v20, v20, v20 row_ror:8 row_mask:0xf bank_mask:0xf
    v_add_f32 v184, v196, v24
    v_add_f32 v185, v197, v24
    v_add_f32_dpp v20, v20, v20 row_ror:4 row_mask:0xf bank_mask:0xf
    v_add_f32 v186, v198, v24
    v_add_f32 v187, v199, v24
    v_add_f32_dpp v20, v20, v20 row_ror:2 row_mask:0xf bank_mask:0xf
    v_add_f32 v188, v200, v24
    v_add_f32 v189, v201, v24
    v_add_f32_dpp v20, v20, v20 row_ror:1 row_mask:0xf bank_mask:0xf
    v_add_f32 v190, v202, v24
    v_add_f32 v191, v203, v24
    v_add_f32_dpp v20, v20, v20 row_bcast:15 row_mask:0xa bank_mask:0xf
    v_add_f32 v192, v204, v24
    v_add_f32 v193, v205, v24
    v_add_f32_dpp v20, v20, v20 row_bcast:31 row_mask:0xc bank_mask:0xf
    v_add_f32 v194, v206, v24
    v_add_f32 v195, v207, v24
    v_readlane_b32 s4, v20, 63
    v_cvt_pk_bf16_f32 v208, v184, v185
    v_cvt_pk_bf16_f32 v209, v186, v187
    v_mul_f32 v20, s4, -v214
    v_cvt_pk_bf16_f32 v210, v188, v189
    v_cvt_pk_bf16_f32 v211, v190, v191
    v_cvt_pk_bf16_f32 v20, v20, v20
    v_cvt_pk_bf16_f32 v212, v192, v193
    v_cvt_pk_bf16_f32 v213, v194, v195
    v_and_b32 v20, 0xffff0000, v20
    v_and_b32 v209, v209, v215
    v_and_b32 v211, v211, v215
    v_add_f32 v20, 0x3727c5ac, v20
    v_and_b32 v212, v212, v216
    v_and_b32 v213, v213, v217
    v_cvt_pk_bf16_f32 v20, v20, v20
    v_lshlrev_b32 v184, 16, v208
    v_and_b32 v185, 0xffff0000, v208
    v_and_b32 v20, 0xffff0000, v20
    v_lshlrev_b32 v186, 16, v209
    v_and_b32 v187, 0xffff0000, v209
    v_sqrt_f32 v20, v20
    v_lshlrev_b32 v188, 16, v210
    v_and_b32 v189, 0xffff0000, v210
    v_cvt_pk_bf16_f32 v20, v20, v20
    v_lshlrev_b32 v190, 16, v211
    v_and_b32 v191, 0xffff0000, v211
    v_and_b32 v20, 0xffff0000, v20
    v_lshlrev_b32 v192, 16, v212
    v_and_b32 v193, 0xffff0000, v212
    v_rcp_f32 v25, v20
    v_lshlrev_b32 v194, 16, v213
    v_and_b32 v195, 0xffff0000, v213
    v_mul_f32 v184, v184, v25
    v_mul_f32 v185, v185, v25
    v_mul_f32 v186, v186, v25
    v_mul_f32 v187, v187, v25
    v_mul_f32 v188, v188, v25
    v_mul_f32 v189, v189, v25
    v_mul_f32 v190, v190, v25
    v_mul_f32 v191, v191, v25
    v_mul_f32 v192, v192, v25
    v_mul_f32 v193, v193, v25
    v_mul_f32 v194, v194, v25
    v_mul_f32 v195, v195, v25
    v_cvt_pk_bf16_f32 v196, v184, v185
    v_cvt_pk_bf16_f32 v197, v186, v187
    v_cvt_pk_bf16_f32 v198, v188, v189
    v_cvt_pk_bf16_f32 v199, v190, v191
    v_cvt_pk_bf16_f32 v200, v192, v193
    v_cvt_pk_bf16_f32 v201, v194, v195
    ds_write_b64 v18, v[196:197] offset:9216
    ds_write_b64 v18, v[198:199] offset:9728
    s_mov_b32 exec_hi, 0xffff
    ds_write_b64 v18, v[200:201] offset:10240
    s_mov_b32 exec_hi, -1
    s_waitcnt lgkmcnt(0)
    s_barrier
    s_cmp_ge_u32 s3, 4
    s_cbranch_scc1 L_fin
    ds_read_b128 v[136:139], v19 offset:9216
    ds_read_b128 v[140:143], v19 offset:9344
    ds_read_b128 v[144:147], v19 offset:9472
    ds_read_b128 v[148:151], v19 offset:9600
    ds_read_b128 v[152:155], v19 offset:9728
    ds_read_b128 v[156:159], v19 offset:9856
    ds_read_b128 v[160:163], v19 offset:9984
    ds_read_b128 v[164:167], v19 offset:10112
    ds_read_b128 v[168:171], v19 offset:10240
    ds_read_b128 v[172:175], v19 offset:10368
    ds_read_b128 v[176:179], v19 offset:10496
    s_waitcnt lgkmcnt(10)
    v_mfma_f32_16x16x32_bf16 v[20:23], v[48:51], v[136:139], 0
    v_mfma_f32_16x16x32_bf16 v[24:27], v[52:55], v[136:139], 0
    s_waitcnt lgkmcnt(9)
    v_mfma_f32_16x16x32_bf16 v[20:23], v[56:59], v[140:143], v[20:23]
    v_mfma_f32_16x16x32_bf16 v[24:27], v[60:63], v[140:143], v[24:27]
    s_waitcnt lgkmcnt(8)
    v_mfma_f32_16x16x32_bf16 v[20:23], v[64:67], v[144:147], v[20:23]
    v_mfma_f32_16x16x32_bf16 v[24:27], v[68:71], v[144:147], v[24:27]
    s_waitcnt lgkmcnt(7)
    v_mfma_f32_16x16x32_bf16 v[20:23], v[72:75], v[148:151], v[20:23]
    v_mfma_f32_16x16x32_bf16 v[24:27], v[76:79], v[148:151], v[24:27]
    s_waitcnt lgkmcnt(6)
    v_mfma_f32_16x16x32_bf16 v[20:23], v[80:83], v[152:155], v[20:23]
    v_mfma_f32_16x16x32_bf16 v[24:27], v[84:87], v[152:155], v[24:27]
    s_waitcnt lgkmcnt(5)
    v_mfma_f32_16x16x32_bf16 v[20:23], v[88:91], v[156:159], v[20:23]
    v_mfma_f32_16x16x32_bf16 v[24:27], v[92:95], v[156:159], v[24:27]
    s_waitcnt lgkmcnt(4)
    v_mfma_f32_16x16x32_bf16 v[20:23], v[96:99], v[160:163], v[20:23]
    v_mfma_f32_16x16x32_bf16 v[24:27], v[100:103], v[160:163], v[24:27]
    s_waitcnt lgkmcnt(3)
    v_mfma_f32_16x16x32_bf16 v[20:23], v[104:107], v[164:167], v[20:23]
    v_mfma_f32_16x16x32_bf16 v[24:27], v[108:111], v[164:167], v[24:27]
    s_waitcnt lgkmcnt(2)
    v_mfma_f32_16x16x32_bf16 v[20:23], v[112:115], v[168:171], v[20:23]
    v_mfma_f32_16x16x32_bf16 v[24:27], v[116:119], v[168:171], v[24:27]
    s_waitcnt lgkmcnt(1)
    v_mfma_f32_16x16x32_bf16 v[20:23], v[120:123], v[172:175], v[20:23]
    v_mfma_f32_16x16x32_bf16 v[24:27], v[124:127], v[172:175], v[24:27]
    s_waitcnt lgkmcnt(0)
    v_mfma_f32_16x16x32_bf16 v[20:23], v[128:131], v[176:179], v[20:23]
    v_mfma_f32_16x16x32_bf16 v[24:27], v[132:135], v[176:179], v[24:27]
    s_nop 7
    v_add_f32_dpp v20, v24, v20 row_ror:8 row_mask:0xf bank_mask:0xf
    v_add_f32_dpp v21, v25, v21 row_ror:8 row_mask:0xf bank_mask:0xf
    v_add_f32_dpp v22, v26, v22 row_ror:8 row_mask:0xf bank_mask:0xf
    v_add_f32_dpp v23, v27, v23 row_ror:8 row_mask:0xf bank_mask:0xf
    v_max_f32 v20, 0, v20
    v_max_f32 v21, 0, v21
    v_max_f32 v22, 0, v22
    v_max_f32 v23, 0, v23
    v_cvt_pk_bf16_f32 v24, v20, v21
    v_cvt_pk_bf16_f32 v25, v22, v23
    s_mov_b64 exec, s[10:11]
    buffer_store_dwordx2 v[24:25], v16, s[64:67], s7 offen sc1
    s_branch L_fin
L_ffn2:
    s_mov_b64 s[22:23], 0
    s_mov_b32 s100, 2
    s_mov_b32 s56, s18
    s_and_b32 s57, s19, 0xffff
    v_lshrrev_b32 v10, 2, v0
    v_mul_u32_u24 v10, 1280, v10
    v_and_b32 v21, 3, v0
    v_lshl_add_u32 v10, v21, 4, v10
    s_mul_i32 s12, s3, 286720
    s_mul_i32 s5, s101, 64
    s_add_u32 s12, s12, s5
    s_mul_i32 s7, s3, 14336
    s_add_u32 s7, s7, 35840
    s_mov_b32 s13, s7
    s_barrier
    s_mov_b32 m0, s13
    s_nop 0
    buffer_load_dwordx4 v10, s[56:59], s12 offen lds
    s_add_u32 s12, s12, 20480
    s_add_u32 s13, s13, 1024
    s_mov_b32 m0, s13
    s_nop 0
    buffer_load_dwordx4 v10, s[56:59], s12 offen lds
    s_add_u32 s12, s12, 20480
    s_add_u32 s13, s13, 1024
    s_mov_b32 m0, s13
    s_nop 0
    buffer_load_dwordx4 v10, s[56:59], s12 offen lds
    s_add_u32 s12, s12, 20480
    s_add_u32 s13, s13, 1024
    s_mov_b32 m0, s13
    s_nop 0
    buffer_load_dwordx4 v10, s[56:59], s12 offen lds
    s_add_u32 s12, s12, 20480
    s_add_u32 s13, s13, 1024
    s_mov_b32 m0, s13
    s_nop 0
    buffer_load_dwordx4 v10, s[56:59], s12 offen lds
    s_add_u32 s12, s12, 20480
    s_add_u32 s13, s13, 1024
    s_mov_b32 m0, s13
    s_nop 0
    buffer_load_dwordx4 v10, s[56:59], s12 offen lds
    s_add_u32 s12, s12, 20480
    s_add_u32 s13, s13, 1024
    s_mov_b32 m0, s13
    s_nop 0
    buffer_load_dwordx4 v10, s[56:59], s12 offen lds
    s_add_u32 s12, s12, 20480
    s_add_u32 s13, s13, 1024
    s_mov_b32 m0, s13
    s_nop 0
    buffer_load_dwordx4 v10, s[56:59], s12 offen lds
    s_add_u32 s12, s12, 20480
    s_add_u32 s13, s13, 1024
    s_mov_b32 m0, s13
    s_nop 0
    buffer_load_dwordx4 v10, s[56:59], s12 offen lds
    s_add_u32 s12, s12, 20480
    s_add_u32 s13, s13, 1024
    s_mov_b32 m0, s13
    s_nop 0
    buffer_load_dwordx4 v10, s[56:59], s12 offen lds
    s_add_u32 s12, s12, 20480
    s_add_u32 s13, s13, 1024
    s_mov_b32 m0, s13
    s_nop 0
    buffer_load_dwordx4 v10, s[56:59], s12 offen lds
    s_add_u32 s12, s12, 20480
    s_add_u32 s13, s13, 1024
    s_mov_b32 m0, s13
    s_nop 0
    buffer_load_dwordx4 v10, s[56:59], s12 offen lds
    s_add_u32 s12, s12, 20480
    s_add_u32 s13, s13, 1024
    s_mov_b32 m0, s13
    s_nop 0
    buffer_load_dwordx4 v10, s[56:59], s12 offen lds
    s_add_u32 s12, s12, 20480
    s_add_u32 s13, s13, 1024
    s_mov_b32 m0, s13
    s_nop 0
    buffer_load_dwordx4 v10, s[56:59], s12 offen lds
    v_and_b32 v8, 7, v0
    v_mul_u32_u24 v9, 1280, v8
    v_lshl_add_u32 v9, v28, 3, v9
    s_and_b32 s8, s3, 1
    s_lshl_b32 s8, s8, 5
    s_add_u32 s5, s5, s8
    buffer_load_dwordx2 v[32:33], v9, s[44:47], s5 offen
    s_lshr_b32 s4, s5, 1
    v_lshl_add_u32 v20, v28, 2, s4
    v_mul_u32_u24 v21, 3072, v8
    v_add_u32 v22, 0, v20
    v_mul_u32_u24 v23, 4370, v22
    v_lshrrev_b32 v23, 16, v23
    v_add_u32 v22, v22, v23
    v_lshl_add_u32 v176, v22, 2, v21
    v_lshl_add_u32 v180, v23, 6, v21
    v_add_u32 v22, 1, v20
    v_mul_u32_u24 v23, 4370, v22
    v_lshrrev_b32 v23, 16, v23
    v_add_u32 v22, v22, v23
    v_lshl_add_u32 v177, v22, 2, v21
    v_add_u32 v22, 2, v20
    v_mul_u32_u24 v23, 4370, v22
    v_lshrrev_b32 v23, 16, v23
    v_add_u32 v22, v22, v23
    v_lshl_add_u32 v178, v22, 2, v21
    v_add_u32 v22, 3, v20
    v_mul_u32_u24 v23, 4370, v22
    v_lshrrev_b32 v23, 16, v23
    v_add_u32 v22, v22, v23
    v_lshl_add_u32 v179, v22, 2, v21
    v_lshl_add_u32 v181, v23, 6, v21
    v_lshrrev_b32 v17, 1, v28
    v_lshlrev_b32 v17, 8, v17
    v_lshl_add_u32 v17, v8, 5, v17
    v_and_b32 v18, 1, v28
    v_lshl_add_u32 v17, v18, 4, v17
    v_lshrrev_b32 v18, 3, v29
    v_lshl_add_u32 v17, v18, 9, v17
    v_mul_u32_u24 v18, 512, v28
    v_lshrrev_b32 v19, 2, v29
    v_lshl_add_u32 v18, v19, 6, v18
    v_and_b32 v19, 3, v29
    v_lshl_add_u32 v18, v19, 3, v18
    v_add_u32 v18, s7, v18
    s_lshl_b32 s4, s3, 11
    v_add_u32 v12, s4, v1
    s_lshl_b32 s4, s8, 5
    v_add_u32 v13, s4, v1
    s_mul_i32 s6, s3, 3584
L_f2_top:
    s_mov_b64 exec, s[22:23]
    s_cbranch_execz L_f2_got
    s_waitcnt vmcnt(0)
    ds_read_b64_tr_b16 v[48:49], v18 offset:0
    ds_read_b64_tr_b16 v[50:51], v18 offset:256
    ds_read_b64_tr_b16 v[52:53], v18 offset:32
    ds_read_b64_tr_b16 v[54:55], v18 offset:288
    ds_read_b64_tr_b16 v[56:57], v18 offset:2048
    ds_read_b64_tr_b16 v[58:59], v18 offset:2304
    ds_read_b64_tr_b16 v[60:61], v18 offset:2080
    ds_read_b64_tr_b16 v[62:63], v18 offset:2336
    ds_read_b64_tr_b16 v[64:65], v18 offset:4096
    ds_read_b64_tr_b16 v[66:67], v18 offset:4352
    ds_read_b64_tr_b16 v[68:69], v18 offset:4128
    ds_read_b64_tr_b16 v[70:71], v18 offset:4384
    ds_read_b64_tr_b16 v[72:73], v18 offset:6144
    ds_read_b64_tr_b16 v[74:75], v18 offset:6400
    ds_read_b64_tr_b16 v[76:77], v18 offset:6176
    ds_read_b64_tr_b16 v[78:79], v18 offset:6432
    ds_read_b64_tr_b16 v[80:81], v18 offset:8192
    ds_read_b64_tr_b16 v[82:83], v18 offset:8448
    ds_read_b64_tr_b16 v[84:85], v18 offset:8224
    ds_read_b64_tr_b16 v[86:87], v18 offset:8480
    ds_read_b64_tr_b16 v[88:89], v18 offset:10240
    ds_read_b64_tr_b16 v[90:91], v18 offset:10496
    ds_read_b64_tr_b16 v[92:93], v18 offset:10272
    ds_read_b64_tr_b16 v[94:95], v18 offset:10528
    ds_read_b64_tr_b16 v[96:97], v18 offset:12288
    ds_read_b64_tr_b16 v[98:99], v18 offset:12544
    ds_read_b64_tr_b16 v[100:101], v18 offset:12320
    ds_read_b64_tr_b16 v[102:103], v18 offset:12576
    v_lshlrev_b32 v40, 16, v32
    v_and_b32 v41, 0xffff0000, v32
    v_lshlrev_b32 v42, 16, v33
    v_and_b32 v43, 0xffff0000, v33
    s_waitcnt lgkmcnt(0)
    s_cmp_ge_u32 s3, 2
    s_cbranch_scc1 L_f2_go
L_f2_c:
    buffer_load_dword v20, v180, s[48:51], 0 offen offset:60 sc1
    buffer_load_dword v21, v181, s[48:51], 0 offen offset:60 sc1
    s_waitcnt vmcnt(0)
    v_min_f32 v20, v20, v21
    v_cmp_gt_f32 vcc, 0x42000000, v20
    s_nop 3
    s_cbranch_vccz L_f2_c_ok
    s_sub_u32 s9, s9, 1
    s_cmp_lt_i32 s9, 0
    s_cbranch_scc1 L_f2_c_ok
    s_sleep 4
    s_branch L_f2_c
L_f2_c_ok:
    buffer_load_dword v36, v176, s[48:51], 0 offen sc1
    buffer_load_dword v37, v177, s[48:51], 0 offen sc1
    buffer_load_dword v38, v178, s[48:51], 0 offen sc1
    buffer_load_dword v39, v179, s[48:51], 0 offen sc1
L_f2_go:
    s_barrier
L_f2_poll2:
    buffer_load_dwordx4 v[112:115], v17, s[64:67], s6 offen offset:0 sc1
    buffer_load_dwordx4 v[116:119], v17, s[64:67], s6 offen offset:1024 sc1
    buffer_load_dwordx4 v[120:123], v17, s[64:67], s6 offen offset:2048 sc1
    buffer_load_dwordx4 v[124:127], v17, s[64:67], s6 offen offset:3072 sc1
    s_waitcnt vmcnt(0)
    v_max3_u32 v20, v112, v113, v114
    v_max3_u32 v21, v115, v116, v117
    v_max3_u32 v21, v21, v118, v119
    v_max3_u32 v20, v20, v120, v121
    v_max3_u32 v21, v21, v122, v123
    v_max3_u32 v20, v20, v124, v125
    v_max3_u32 v21, v21, v126, v127
    v_max_u32 v20, v20, v21
    v_cmp_eq_u32 vcc, -1, v20
    s_nop 3
    s_cbranch_vccz L_f2_got
    s_sub_u32 s9, s9, 1
    s_cmp_lt_i32 s9, 0
    s_cbranch_scc1 L_f2_got
    s_sleep 1
    s_branch L_f2_poll2
L_f2_got:
    v_mfma_f32_16x16x32_bf16 v[144:147], v[48:51], v[112:115], 0
    v_mfma_f32_16x16x32_bf16 v[152:155], v[52:55], v[112:115], 0
    v_mfma_f32_16x16x32_bf16 v[148:151], v[56:59], v[112:115], 0
    v_mfma_f32_16x16x32_bf16 v[156:159], v[60:63], v[112:115], 0
    v_mfma_f32_16x16x32_bf16 v[144:147], v[64:67], v[116:119], v[144:147]
    v_mfma_f32_16x16x32_bf16 v[152:155], v[68:71], v[116:119], v[152:155]
    v_mfma_f32_16x16x32_bf16 v[148:151], v[72:75], v[116:119], v[148:151]
    v_mfma_f32_16x16x32_bf16 v[156:159], v[76:79], v[116:119], v[156:159]
    v_mfma_f32_16x16x32_bf16 v[144:147], v[80:83], v[120:123], v[144:147]
    v_mfma_f32_16x16x32_bf16 v[152:155], v[84:87], v[120:123], v[152:155]
    v_mfma_f32_16x16x32_bf16 v[148:151], v[88:91], v[120:123], v[148:151]
    v_mfma_f32_16x16x32_bf16 v[156:159], v[92:95], v[120:123], v[156:159]
    v_mfma_f32_16x16x32_bf16 v[144:147], v[96:99], v[124:127], v[144:147]
    v_mfma_f32_16x16x32_bf16 v[152:155], v[100:103], v[124:127], v[152:155]
    v_cvt_pk_bf16_f32 v37, v36, v37
    v_cvt_pk_bf16_f32 v39, v38, v39
    v_lshlrev_b32 v36, 16, v37
    v_and_b32 v37, 0xffff0000, v37
    v_lshlrev_b32 v38, 16, v39
    v_and_b32 v39, 0xffff0000, v39
    v_add_f32 v44, v40, v36
    v_add_f32 v45, v41, v37
    v_add_f32 v46, v42, v38
    v_add_f32 v47, v43, v39
    v_cvt_pk_bf16_f32 v45, v44, v45
    v_cvt_pk_bf16_f32 v47, v46, v47
    v_lshlrev_b32 v44, 16, v45
    v_and_b32 v45, 0xffff0000, v45
    v_lshlrev_b32 v46, 16, v47
    v_and_b32 v47, 0xffff0000, v47
    v_cndmask_b32 v144, v148, v144, s[10:11]
    v_cndmask_b32 v145, v149, v145, s[10:11]
    v_cndmask_b32 v146, v150, v146, s[10:11]
    v_cndmask_b32 v147, v151, v147, s[10:11]
    ds_write_b128 v12, v[144:147] offset:9216
    v_cndmask_b32 v152, v156, v152, s[10:11]
    v_cndmask_b32 v153, v157, v153, s[10:11]
    v_cndmask_b32 v154, v158, v154, s[10:11]
    v_cndmask_b32 v155, v159, v155, s[10:11]
    ds_write_b128 v12, v[152:155] offset:10240
    s_waitcnt lgkmcnt(0)
    s_barrier
    s_cmp_ge_u32 s3, 2
    s_cbranch_scc1 L_f2_next
    ds_read_b128 v[192:195], v13 offset:9216
    ds_read_b128 v[196:199], v13 offset:11264
    ds_read_b128 v[200:203], v13 offset:13312
    ds_read_b128 v[204:207], v13 offset:15360
    ds_read_b128 v[208:211], v13 offset:17408
    ds_read_b128 v[212:215], v13 offset:19456
    ds_read_b128 v[216:219], v13 offset:21504
    ds_read_b128 v[220:223], v13 offset:23552
    s_waitcnt lgkmcnt(6)
    v_add_f32 v192, v192, v196
    v_add_f32 v193, v193, v197
    v_add_f32 v194, v194, v198
    v_add_f32 v195, v195, v199
    s_waitcnt lgkmcnt(4)
    v_add_f32 v200, v200, v204
    v_add_f32 v201, v201, v205
    v_add_f32 v202, v202, v206
    v_add_f32 v203, v203, v207
    v_add_f32 v192, v192, v200
    v_add_f32 v193, v193, v201
    v_add_f32 v194, v194, v202
    v_add_f32 v195, v195, v203
    s_waitcnt lgkmcnt(2)
    v_add_f32 v208, v208, v212
    v_add_f32 v209, v209, v213
    v_add_f32 v210, v210, v214
    v_add_f32 v211, v211, v215
    s_waitcnt lgkmcnt(0)
    v_add_f32 v216, v216, v220
    v_add_f32 v217, v217, v221
    v_add_f32 v218, v218, v222
    v_add_f32 v219, v219, v223
    v_add_f32 v208, v208, v216
    v_add_f32 v209, v209, v217
    v_add_f32 v210, v210, v218
    v_add_f32 v211, v211, v219
    v_add_f32 v192, v192, v208
    v_add_f32 v193, v193, v209
    v_add_f32 v194, v194, v210
    v_add_f32 v195, v195, v211
    v_add_f32_dpp v192, v192, v192 row_ror:8 row_mask:0xf bank_mask:0xf
    v_add_f32_dpp v193, v193, v193 row_ror:8 row_mask:0xf bank_mask:0xf
    v_add_f32_dpp v194, v194, v194 row_ror:8 row_mask:0xf bank_mask:0xf
    v_add_f32_dpp v195, v195, v195 row_ror:8 row_mask:0xf bank_mask:0xf
    v_cvt_pk_bf16_f32 v193, v192, v193
    v_cvt_pk_bf16_f32 v195, v194, v195
    v_lshlrev_b32 v192, 16, v193
    v_and_b32 v193, 0xffff0000, v193
    v_lshlrev_b32 v194, 16, v195
    v_and_b32 v195, 0xffff0000, v195
    v_add_f32 v192, v44, v192
    v_add_f32 v193, v45, v193
    v_add_f32 v194, v46, v194
    v_add_f32 v195, v47, v195
    v_cvt_pk_bf16_f32 v24, v192, v193
    v_cvt_pk_bf16_f32 v25, v194, v195
    s_and_b64 exec, exec, s[10:11]
    s_nop 0
    s_cbranch_execz L_f2_next
    buffer_store_dwordx2 v[24:25], v9, s[60:63], s5 offen
L_f2_next:
    s_cmp_lg_u32 s22, 0
    s_cbranch_scc1 L_fin
    s_mov_b64 s[22:23], -1
    s_branch L_f2_top
L_fin:
L_end:
    s_endpgm
L_codeend:
.section .rodata,"a"
.p2align 6
.amdhsa_kernel sequential_preLN__sliding_block_cached__dense_activation_relu__decode_kernel
  .amdhsa_next_free_vgpr 256
  .amdhsa_next_free_sgpr 102
  .amdhsa_accum_offset 256
  .amdhsa_group_segment_fixed_size 0
  .amdhsa_kernarg_size 88
  .amdhsa_user_sgpr_count 2
  .amdhsa_user_sgpr_kernarg_segment_ptr 1
  .amdhsa_system_sgpr_workgroup_id_x 1
  .amdhsa_float_denorm_mode_32 3
.end_amdhsa_kernel
```
